```python
import torch

def _softmax(x, axis=-1):
    return torch.softmax(x, dim=axis)
def _gelu(x):
    return torch.nn.functional.gelu(x, approximate="tanh")
def _silu(x):
    return torch.nn.functional.silu(x)
def _sigmoid(x):
    return torch.sigmoid(x)
def _layernorm(x, axis=-1, eps=1e-5):
    m = x.mean(dim=axis, keepdim=True)
    v = x.var(dim=axis, keepdim=True, unbiased=False)
    return (x - m) / torch.sqrt(v + eps)
def _scatter_add(tgt, idx, src, axis=0):
    return tgt.clone().index_add_(axis, idx, src)
def _segment_sum(src, seg, n):
    out = torch.zeros((n,) + src.shape[1:], dtype=src.dtype)
    return out.index_add_(0, seg, src)
def _pad(x, pw):
    flat = tuple(v for pair in reversed(pw) for v in pair)
    return torch.nn.functional.pad(x, flat)

kernel_name = 'parallel_sum__ssm_conv_s4__glu_gated_glu__prompt'

def setup_inputs():

    _w = (lambda a: (lambda t: t.to(torch.bfloat16) if t.is_floating_point() else t)(torch.as_tensor(a)))
    def _A_setup():
        B, L, D, N = 1, 2048, 448, 256
        A_re = -(lambda _x: torch.exp(torch.as_tensor(_x)))((lambda *s: torch.randn(*s, dtype=torch.bfloat16) * 6.4)(D, N))
        A_im = torch.pi * (lambda *s: torch.randn(*s, dtype=torch.bfloat16) * 0.1)(D, N)
        B_re = (lambda *s: torch.randn(*s, dtype=torch.bfloat16) * 0.2)(D, N)
        B_im = (lambda *s: torch.randn(*s, dtype=torch.bfloat16) * 0.2)(D, N)
        C_re = (lambda *s: torch.randn(*s, dtype=torch.bfloat16) * 0.2)(D, N)
        C_im = (lambda *s: torch.randn(*s, dtype=torch.bfloat16) * 0.2)(D, N)
        log_dt = (lambda *s: torch.randn(*s, dtype=torch.bfloat16) * 0.1)(D) * 0.5 - 4.0
        Dskip = (lambda *s: torch.randn(*s, dtype=torch.bfloat16) * 0.1)(D)
        return {
            "u": _w((lambda *s: torch.randn(*s, dtype=torch.bfloat16) * 0.05)(B, L, D)),
            "A_re": _w(A_re),
            "A_im": _w(A_im),
            "B_re": _w(B_re),
            "B_im": _w(B_im),
            "C_re": _w(C_re),
            "C_im": _w(C_im),
            "log_dt": _w(log_dt),
            "Dskip": _w(Dskip),
        }
    _A_in = _A_setup()

    def _B_setup():
        B, S, D, F = 1, 2048, 448, 1792
        return {
            "x": _w((lambda *s: torch.randn(*s, dtype=torch.bfloat16) * 0.05)(B, S, D)),
            "w_gate": _w((lambda *s: torch.randn(*s, dtype=torch.bfloat16) * 0.05)(D, F)),
            "w_up": _w((lambda *s: torch.randn(*s, dtype=torch.bfloat16) * 0.05)(D, F)),
            "w_down": _w((lambda *s: torch.randn(*s, dtype=torch.bfloat16) * 0.05)(F, D)),
        }
    _B_in = _B_setup()

    return {
        "A_u": _A_in["u"],
        "A_A_re": _A_in["A_re"],
        "A_A_im": _A_in["A_im"],
        "A_B_re": _A_in["B_re"],
        "A_B_im": _A_in["B_im"],
        "A_C_re": _A_in["C_re"],
        "A_C_im": _A_in["C_im"],
        "A_log_dt": _A_in["log_dt"],
        "A_Dskip": _A_in["Dskip"],
        "B_x": _B_in["x"],
        "B_w_gate": _B_in["w_gate"],
        "B_w_up": _B_in["w_up"],
        "B_w_down": _B_in["w_down"],
    }

def reference(A_u, A_A_re, A_A_im, A_B_re, A_B_im, A_C_re, A_C_im, A_log_dt, A_Dskip, B_x, B_w_gate, B_w_up, B_w_down):
    def _A_ref(u, A_re, A_im, B_re, B_im, C_re, C_im, log_dt, Dskip):
        Bsz, L, D = u.shape
        dt = torch.exp(log_dt)[:, None]
        A = A_re + 1j * A_im
        Bc = B_re + 1j * B_im
        Cc = C_re + 1j * C_im
        logdA = dt * A
        dB = dt * Bc
        l = (lambda x, dt: x.to(dt))(torch.arange(L), A_re.dtype)
        P = torch.exp(logdA[:, :, None] * l[None, None, :])
        K = torch.einsum("dn,dnl,dn->dl", Cc, P, dB).real
        L2 = 2 * L
        Kp = _pad(K, ((0, 0), (0, L)))
        up = (lambda x, *d: x.permute(*d))(u, 0, 2, 1)
        up = _pad(up, ((0, 0), (0, 0), (0, L)))
        Kf = (lambda x, axes=(-2,-1): torch.fft.rfft2(x.float(), dim=axes))(Kp[:, None, :], axes=(-2, -1))
        Uf = (lambda x, axes=(-2,-1): torch.fft.rfft2(x.float(), dim=axes))(up[:, :, None, :], axes=(-2, -1))
        Yf = Uf * Kf[None, :, :, :]
        y = (lambda x, s, axes=(-2,-1): torch.fft.irfft2(x, s=s, dim=axes).to(torch.bfloat16))(Yf, (1, L2), axes=(-2, -1))[:, :, 0, :L]
        y = (lambda x, *d: x.permute(*d))(y, 0, 2, 1) + u * Dskip[None, None, :]
        return y

    def _B_ref(x, w_gate, w_up, w_down):
        g = torch.einsum("bsd,df->bsf", x, w_gate)
        u = torch.einsum("bsd,df->bsf", x, w_up)
        h = _sigmoid(g) * u
        return torch.einsum("bsf,fd->bsd", h, w_down)

    x = A_u
    xn = _layernorm(x, axis=-1)
    return x + _A_ref(xn, A_A_re, A_A_im, A_B_re, A_B_im, A_C_re, A_C_im, A_log_dt, A_Dskip) + _B_ref(xn, B_w_gate, B_w_up, B_w_down)
```

```asm
; @launch grid=(256,1,1) block=(512,1,1) lds=163840
.amdgcn_target "amdgcn-amd-amdhsa--gfx950"
.text
.globl parallel_sum__ssm_conv_s4__glu_gated_glu__prompt_kernel
.p2align 12
.p2align 8
.type parallel_sum__ssm_conv_s4__glu_gated_glu__prompt_kernel,@function
parallel_sum__ssm_conv_s4__glu_gated_glu__prompt_kernel:
    s_load_dwordx16 s[4:19], s[0:1], 0
    s_load_dwordx16 s[20:35], s[0:1], 64
    v_and_b32_e64 v53, 56, v0
    s_cmp_ge_u32 s2, 256
    s_cbranch_scc1 L_exit
    global_load_dwordx2 v[46:47], v53, s[0:1] offset:8
    s_getpc_b64 s[82:83]
L_pc:
    v_lshrrev_b32 v2, 6, v0
    s_lshr_b32 s92, s2, 3
    v_lshlrev_b32 v1, 4, v0
    s_lshl_b32 s85, s2, 6
    v_readfirstlane_b32 s3, v2
    v_and_b32 v6, 63, v0
    s_add_u32 s85, s85, L_wgtab-L_pc
    s_and_b32 s93, s2, 7
    s_cmp_ge_u32 s2, 32
    s_cbranch_scc1 L_nowarm
    v_and_b32_e64 v3, 15, v0
    s_lshl_b32 s84, s92, 10
    v_lshl_add_u32 v4, v2, 7, s84
    v_lshl_add_u32 v3, v3, 12, v4
    v_min_u32 v3, L_wgtab-L_pc+16380, v3
    global_load_dword v4, v3, s[82:83]
L_nowarm:
    s_lshl_b32 s84, s93, 5
    v_cmp_gt_u32 vcc, 56, v6
    s_add_u32 s84, s84, s92
    v_lshlrev_b32 v3, 4, v6
    s_and_b32 s77, s84, 1
    v_cndmask_b32 v55, -1, v3, vcc
    s_mul_i32 s77, s77, -6
    v_cmp_eq_u32_e64 vcc, 56, v6
    s_lshl3_add_u32 s77, s84, s77
    s_lshr_b32 s94, s3, 2
    s_and_b32 s95, s3, 3
    s_add_u32 s77, s77, s94
    s_lshl2_add_u32 s77, s95, s77
    s_mul_i32 s77, s77, 896
    s_mov_b32 s38, 1835008
    s_mov_b32 s39, 0x20000
    s_cmp_lt_u32 s2, 32
    s_cbranch_scc1 L_helper
    s_mul_i32 s76, s93, 28
    v_mov_b32 v144, 0
    s_add_u32 s76, s76, s92
    v_mov_b32 v145, 0
    s_sub_u32 s76, s76, 4
    v_mov_b32 v146, 0
    s_and_b32 s84, s92, 3
    v_mov_b32 v147, 0
    s_and_b32 s78, s93, 6
    v_mov_b32 v148, 0
    s_lshl1_add_u32 s78, s78, s84
    v_mov_b32 v149, 0
    s_mul_i32 s78, s78, 114688
    v_mov_b32 v150, 0
    s_and_b32 s79, s93, 1
    v_mov_b32 v184, 0
    s_mul_i32 s79, s79, 7
    v_mov_b32 v255, 0
    s_lshr_b32 s84, s92, 2
    v_mov_b32 v48, -1
    s_add_u32 s79, s79, s84
    v_mov_b32 v49, -1
    s_lshl_b32 s79, s79, 8
    v_mov_b32_e64 v50, -1
    s_sub_u32 s79, s79, 256
    v_mov_b32 v51, -1
    s_lshl_b32 s84, s76, 10
    v_mov_b32 v36, 0x3f80
    s_lshl_b32 s81, s3, 7
    v_and_b32 v52, 0x70, v1
    s_add_u32 s84, s84, s81
    v_cmp_gt_u32 s[92:93], 48, v53
    v_add_u32 v52, s84, v52
    s_lshr_b32 s84, s84, 8
    s_and_b32 s80, s84, -16
    v_mov_b32 v53, s80
    s_mul_i32 s97, s3, 4608
    v_cndmask_b32 v52, v53, v52, s[92:93]
    s_add_u32 s97, s97, 98304
    v_mov_b32 v53, 0
    s_and_b32 s84, s84, 14
    v_lshl_add_u32 v37, v6, 1, s97
    s_add_u32 s84, s84, s97
    s_add_u32 m0, s97, 1024
    v_mov_b32_e64 v38, s84
    s_lshl_b32 s81, s3, 11
    s_mov_b32 s42, 1605632
    s_waitcnt vmcnt(0)
    v_lshl_add_u64 v[46:47], v[52:53], 0, v[46:47]
    global_load_lds_dwordx4 v[46:47], off
    s_waitcnt lgkmcnt(0)
    s_mov_b64 s[36:37], s[4:5]
    buffer_load_dwordx4 v[56:59], v55, s[36:39], s77 offen
    s_load_dwordx16 s[60:75], s[82:83], s85
    v_lshrrev_b32 v116, 3, v0
    s_mov_b32 s43, 0x20000
    s_movk_i32 s92, 6144
    s_nop 0
    s_mov_b32 s46, 1606656
    v_lshl_add_u32 v116, v2, 3, v116
    s_mov_b32 s47, 0x20000
    v_and_b32 v108, 48, v0
    s_mov_b64 s[40:41], s[24:25]
    v_mul_u32_u24 v116, 896, v116
    s_sub_u32 s44, s26, 1024
    v_and_b32 v117, 0x70, v1
    s_subb_u32 s45, s27, 0
    v_lshrrev_b32_e64 v109, 4, v0
    s_mov_b64 s[52:53], s[34:35]
    v_xad_u32 v10, v117, v108, v116
    s_mov_b32 s54, 1982464
    v_xad_u32 v11, v10, 64, s92
    s_mov_b32 s55, 0x20000
    v_mul_u32_u24 v116, 3584, v109
    s_mov_b64 s[56:57], s[34:35]
    v_and_b32 v117, 0xf0, v1
    s_mov_b32 s58, 16777216
    v_lshlrev_b32 v118, 2, v108
    s_mov_b32 s59, 0x20000
    v_xad_u32 v12, v117, v118, v116
    v_xor_b32_e64 v13, 32, v12
    v_lshl_add_u32 v236, v2, 6, v1
    v_and_b32 v116, 48, v1
    v_and_b32 v115, -4, v0
    s_movk_i32 s92, 1088
    v_lshrrev_b32 v111, 1, v116
    v_lshl_add_u32 v238, v115, 12, v116
    v_bfe_u32 v110, v0, 2, 2
    v_lshrrev_b32_e64 v109, 4, v0
    v_lshl_add_u32 v116, v109, 5, v111
    v_mad_u32_u24 v237, v110, s92, v116
    v_add_u32 v236, 135168, v236
    v_add_u32 v237, 135168, v237
    v_and_b32 v112, 15, v0
    s_movk_i32 s92, 288
    v_add_u32_e64 v116, s97, v108
    s_mul_i32 s93, s3, 3072
    v_mad_u32_u24 v239, v112, s92, v116
    s_add_u32 s93, s93, 135168
    v_bfe_u32 v114, v0, 5, 1
    v_lshl_add_u32 v116, v108, 4, s93
    v_sub_u32_e64 v117, 4, v114
    v_lshl_add_u32 v43, v112, 2, v116
    s_movk_i32 s92, 120
    s_nop 0
    v_lshl_add_u32 v41, v112, v117, v116
    v_lshl_add_u32 v116, v114, 4, v112
    v_mad_u32_u24 v42, v114, s92, v41
    v_and_b32_e64 v117, 16, v0
    v_lshl_add_u32 v116, v116, 5, s93
    v_add_u32_e64 v40, v116, v117
    s_add_u32 m0, s81, 65536
    s_nop 0
    buffer_load_dwordx4 v10, s[36:39], s78 offen lds
    buffer_load_dwordx4 v11, s[36:39], s78 offen offset:1024 lds
    s_add_u32 m0, s81, 0
    s_nop 0
    buffer_load_dwordx4 v12, s[40:43], s79 offen lds
    buffer_load_dwordx4 v13, s[44:47], s79 offen offset:1024 lds
    s_movk_i32 s92, 320
    v_bfe_u32 v113, v0, 4, 1
    s_movk_i32 s93, 1056
    s_nop 0
    v_mad_u32_u24 v116, v110, s92, v111
    v_and_b32 v9, 0x3f0, v1
    v_mad_u32_u24 v116, v113, s93, v116
    s_lshl_b32 s92, s95, 6
    v_lshl_add_u32 v116, v114, 12, v116
    s_lshl_b32 s93, s94, 13
    v_xor_b32_e64 v18, s92, v116
    s_add_u32 s93, s93, 65536
    v_xor_b32 v19, 32, v18
    v_and_b32 v116, 31, v0
    v_bfe_u32 v117, v0, 1, 3
    v_lshl_add_u32 v116, v116, 7, s93
    v_xor_b32_e64 v117, v117, v114
    v_lshl_add_u32 v14, v117, 4, v116
    v_xor_b32 v15, 32, v14
    v_xor_b32 v16, 64, v14
    v_xor_b32 v17, 0x60, v14
    v_lshl_add_u32 v116, v115, 5, v111
    v_bfe_u32 v117, v0, 3, 2
    v_lshl_add_u32 v22, v117, 5, v116
    v_lshl_add_u32 v116, v114, 2, v110
    s_mul_i32 s92, s94, 16128
    v_mad_i32_i24 v116, v116, -8, v111
    s_lshl_b32 s93, s3, 7
    v_mul_u32_u24 v117, 8320, v113
    s_add_u32 s92, s92, s93
    s_add_u32 s92, s92, 114752
    v_add3_u32 v6, v116, v117, s92
    s_mul_i32 s92, s94, 5120
    v_add_lshl_u32 v116, v112, v114, 5
    s_sub_u32 s92, s92, s93
    v_and_b32 v117, 16, v0
    s_add_u32 s92, s92, 148384
    v_add3_u32 v7, v116, v117, s92
    v_lshrrev_b32 v186, 7, v9
    v_and_b32 v187, 6, v186
    v_mul_u32_u24 v186, 768, v186
    v_lshlrev_b32_e64 v187, 4, v187
    v_xad_u32 v8, v9, v187, v186
    v_add_u32 v30, 13312, v8
    v_and_b32 v186, 1, v0
    v_lshlrev_b32 v187, 5, v0
    v_mad_i32_i24 v21, v186, -16, v187
    v_mul_u32_u24 v186, 4600, v186
    v_lshl_add_u32 v186, v0, 3, v186
    v_add_u32 v20, 148480, v186
    v_and_b32 v186, 16, v0
    v_and_b32 v187, 2, v0
    v_lshl_add_u32 v186, v187, 2, v186
    v_and_or_b32 v186, v0, 1, v186
    v_bfe_u32 v187, v0, 2, 2
    s_lshl_b32 s92, s94, 9
    s_nop 0
    v_lshl_add_u32 v186, v186, 2, v187
    s_add_u32 s92, s92, 159744
    v_lshl_add_u32 v248, v186, 1, s92
    s_lshl_b32 s92, s95, 8
    v_and_b32 v186, 48, v0
    s_add_u32 s92, s92, 160768
    v_min_u32 v186, 32, v186
    v_and_b32 v187, 15, v0
    v_lshl_add_u32 v186, v186, 3, v187
    v_lshl_add_u32 v249, v186, 3, s92
    v_mov_b32 v45, 163832
    s_waitcnt lgkmcnt(0)
    ds_write_b32 v45, v255
    s_mov_b32 m0, s97
    s_setprio 3
    ds_write_addtid_b32 v36
    s_waitcnt vmcnt(5)
    ds_read_u16_d16_hi v150, v38 offset:1792
    ds_read_u16_d16_hi v144, v37 offset:1024
    ds_read_u16_d16_hi v145, v37 offset:1152
    ds_read_u16_d16_hi v146, v37 offset:1280
    ds_read_u16_d16_hi v147, v37 offset:1408
    ds_read_u16_d16_hi v148, v37 offset:1536
    ds_read_u16_d16_hi v149, v37 offset:1664
    ds_read_u16_d16_hi v184, v38 offset:1920
    s_mov_b32 s4, 0x3f803f80
    s_mov_b32 s6, 0xffff0000
    s_waitcnt vmcnt(4)
    s_nop 0
    v_dot2_f32_bf16 v60, v56, s4, 0
    v_dot2_f32_bf16 v61, v56, v56, 0
    v_dot2_f32_bf16 v60, v57, s4, v60
    v_dot2_f32_bf16 v61, v57, v57, v61
    v_dot2_f32_bf16 v60, v58, s4, v60
    v_dot2_f32_bf16 v61, v58, v58, v61
    v_dot2_f32_bf16 v60, v59, s4, v60
    v_dot2_f32_bf16 v61, v59, v59, v61
    v_lshlrev_b32 v96, 16, v56
    v_and_b32 v97, s6, v56
    v_lshlrev_b32 v98, 16, v57
    v_permlane32_swap_b32 v60, v61
    v_add_f32 v60, v60, v61
    v_and_b32 v99, s6, v57
    v_lshlrev_b32_e64 v100, 16, v58
    v_add_f32_dpp v60, v60, v60 quad_perm:[1,0,3,2] row_mask:0xf bank_mask:0xf
    v_and_b32 v101, s6, v58
    v_lshlrev_b32 v102, 16, v59
    v_add_f32_dpp v60, v60, v60 quad_perm:[2,3,0,1] row_mask:0xf bank_mask:0xf
    v_and_b32_e64 v103, s6, v59
    v_mov_b32 v63, 0x3b124925
    v_add_f32_dpp v60, v60, v60 row_half_mirror row_mask:0xf bank_mask:0xf
    s_nop 1
    v_add_f32_dpp v60, v60, v60 row_mirror row_mask:0xf bank_mask:0xf
    s_nop 1
    v_add_f32_dpp v60, v60, v60 row_bcast:15 row_mask:0xa bank_mask:0xf
    s_nop 0
    v_readlane_b32 s4, v60, 16
    v_readlane_b32 s5, v60, 48
    s_nop 0
    v_mul_f32 v60, s4, v63
    v_mul_f32 v62, s5, v63
    v_fma_f32 v62, -v60, v60, v62
    v_max_f32_e64 v62, 0, v62
    v_cvt_pk_bf16_f32 v56, -v60, v62
    v_and_b32_e64 v62, s6, v56
    v_add_f32 v62, 0x3727c5ac, v62
    v_cvt_pk_bf16_f32 v62, v62, v62
    v_and_b32 v62, s6, v62
    v_sqrt_f32 v62, v62
    v_lshlrev_b32_e64 v60, 16, v56
    v_cvt_pk_bf16_f32 v56, v60, v62
    v_and_b32 v62, s6, v56
    v_rcp_f32 v62, v62
    s_nop 0
    v_mul_f32 v60, v60, v62
    v_pk_fma_f32 v[96:97], v[96:97], v[62:63], v[60:61] op_sel_hi:[1,0,0]
    v_pk_fma_f32 v[98:99], v[98:99], v[62:63], v[60:61] op_sel_hi:[1,0,0]
    v_pk_fma_f32 v[100:101], v[100:101], v[62:63], v[60:61] op_sel_hi:[1,0,0]
    v_pk_fma_f32 v[102:103], v[102:103], v[62:63], v[60:61] op_sel_hi:[1,0,0]
    v_cvt_pk_bf16_f32 v96, v96, v97
    v_cvt_pk_bf16_f32 v97, v98, v99
    v_cvt_pk_bf16_f32 v98, v100, v101
    v_cvt_pk_bf16_f32 v99, v102, v103
    v_cndmask_b32_e64 v96, v96, v56, vcc
    ds_write_b128 v236, v[96:99]
    s_waitcnt lgkmcnt(6)
    v_mul_f32 v44, 0x3fb8aa3b, v150
    v_exp_f32 v44, v44
    v_mul_f32_e64 v145, 0.15915494, v145
    v_cvt_pk_bf16_f32 v44, v44, v44
    v_mul_f32 v144, 0x3fb8aa3b, v144
    v_and_b32 v44, 0xffff0000, v44
    v_pk_mul_f32 v[144:145], v[144:145], v[44:45] op_sel_hi:[1,0]
    v_mul_f32 v181, 0x41000000, v145
    v_mul_f32 v180, 0x41000000, v144
    v_fract_f32 v181, v181
    v_exp_f32 v180, v180
    v_cos_f32 v154, v181
    v_sin_f32 v155, v181
    v_fract_f32_e64 v145, v145
    v_pk_mul_f32 v[154:155], v[154:155], v[180:181] op_sel_hi:[1,0] neg_hi:[0,1]
    v_cvt_pk_bf16_f32 v65, v154, v155
    ds_write_addtid_b32 v65 offset:288
    v_pk_mul_f32 v[176:177], v[154:155], v[154:155] op_sel:[0,0] op_sel_hi:[1,0]
    v_pk_fma_f32 v[176:177], v[154:155], v[154:155], v[176:177] op_sel:[1,1,0] op_sel_hi:[0,1,1] neg_lo:[0,1,0]
    v_cvt_pk_bf16_f32 v66, v176, v177
    ds_write_addtid_b32 v66 offset:576
    v_and_b32 v37, 63, v0
    s_lshl3_add_u32 s84, s76, s3
    v_min_u32_e64 v37, 6, v37
    s_mul_i32 s84, s84, 896
    v_lshl_add_u32 v37, v37, 7, s84
    global_load_dword v4, v37, s[28:29]
    v_pk_mul_f32 v[180:181], v[176:177], v[154:155] op_sel:[0,0] op_sel_hi:[1,0]
    v_pk_fma_f32 v[176:177], v[176:177], v[154:155], v[180:181] op_sel:[1,1,0] op_sel_hi:[0,1,1] neg_lo:[0,1,0]
    v_cvt_pk_bf16_f32 v67, v176, v177
    ds_write_addtid_b32 v67 offset:864
    global_load_dword v54, v255, s[34:35]
    v_pk_mul_f32 v[180:181], v[176:177], v[154:155] op_sel:[0,0] op_sel_hi:[1,0]
    v_pk_fma_f32 v[176:177], v[176:177], v[154:155], v[180:181] op_sel:[1,1,0] op_sel_hi:[0,1,1] neg_lo:[0,1,0]
    v_cvt_pk_bf16_f32 v68, v176, v177
    ds_write_addtid_b32 v68 offset:1152
    v_pk_mul_f32 v[180:181], v[176:177], v[154:155] op_sel:[0,0] op_sel_hi:[1,0]
    v_pk_fma_f32 v[176:177], v[176:177], v[154:155], v[180:181] op_sel:[1,1,0] op_sel_hi:[0,1,1] neg_lo:[0,1,0]
    v_cvt_pk_bf16_f32 v69, v176, v177
    ds_write_addtid_b32 v69 offset:1440
    v_pk_mul_f32 v[180:181], v[176:177], v[154:155] op_sel:[0,0] op_sel_hi:[1,0]
    v_pk_fma_f32 v[176:177], v[176:177], v[154:155], v[180:181] op_sel:[1,1,0] op_sel_hi:[0,1,1] neg_lo:[0,1,0]
    v_cvt_pk_bf16_f32 v70, v176, v177
    ds_write_addtid_b32 v70 offset:1728
    v_pk_mul_f32 v[180:181], v[176:177], v[154:155] op_sel:[0,0] op_sel_hi:[1,0]
    v_pk_fma_f32 v[176:177], v[176:177], v[154:155], v[180:181] op_sel:[1,1,0] op_sel_hi:[0,1,1] neg_lo:[0,1,0]
    v_cvt_pk_bf16_f32 v71, v176, v177
    ds_write_addtid_b32 v71 offset:2016
    v_pk_mul_f32 v[180:181], v[176:177], v[154:155] op_sel:[0,0] op_sel_hi:[1,0]
    v_pk_fma_f32 v[176:177], v[176:177], v[154:155], v[180:181] op_sel:[1,1,0] op_sel_hi:[0,1,1] neg_lo:[0,1,0]
    v_cvt_pk_bf16_f32 v72, v176, v177
    ds_write_addtid_b32 v72 offset:2304
    s_setprio 2
    s_nop 0
    v_pk_mul_f32 v[180:181], v[176:177], v[154:155] op_sel:[0,0] op_sel_hi:[1,0]
    v_pk_fma_f32 v[176:177], v[176:177], v[154:155], v[180:181] op_sel:[1,1,0] op_sel_hi:[0,1,1] neg_lo:[0,1,0]
    v_cvt_pk_bf16_f32 v73, v176, v177
    ds_write_addtid_b32 v73 offset:2592
    v_pk_mul_f32 v[180:181], v[176:177], v[154:155] op_sel:[0,0] op_sel_hi:[1,0]
    v_pk_fma_f32 v[176:177], v[176:177], v[154:155], v[180:181] op_sel:[1,1,0] op_sel_hi:[0,1,1] neg_lo:[0,1,0]
    v_cvt_pk_bf16_f32 v74, v176, v177
    ds_write_addtid_b32 v74 offset:2880
    v_pk_mul_f32 v[180:181], v[176:177], v[154:155] op_sel:[0,0] op_sel_hi:[1,0]
    v_pk_fma_f32 v[176:177], v[176:177], v[154:155], v[180:181] op_sel:[1,1,0] op_sel_hi:[0,1,1] neg_lo:[0,1,0]
    v_cvt_pk_bf16_f32 v75, v176, v177
    ds_write_addtid_b32 v75 offset:3168
    v_pk_mul_f32 v[180:181], v[176:177], v[154:155] op_sel:[0,0] op_sel_hi:[1,0]
    v_pk_fma_f32 v[176:177], v[176:177], v[154:155], v[180:181] op_sel:[1,1,0] op_sel_hi:[0,1,1] neg_lo:[0,1,0]
    v_cvt_pk_bf16_f32 v76, v176, v177
    ds_write_addtid_b32 v76 offset:3456
    v_pk_mul_f32 v[180:181], v[176:177], v[154:155] op_sel:[0,0] op_sel_hi:[1,0]
    v_pk_fma_f32 v[176:177], v[176:177], v[154:155], v[180:181] op_sel:[1,1,0] op_sel_hi:[0,1,1] neg_lo:[0,1,0]
    v_cvt_pk_bf16_f32 v77, v176, v177
    ds_write_addtid_b32 v77 offset:3744
    v_pk_mul_f32 v[180:181], v[176:177], v[154:155] op_sel:[0,0] op_sel_hi:[1,0]
    v_pk_fma_f32 v[176:177], v[176:177], v[154:155], v[180:181] op_sel:[1,1,0] op_sel_hi:[0,1,1] neg_lo:[0,1,0]
    v_cvt_pk_bf16_f32 v78, v176, v177
    ds_write_addtid_b32 v78 offset:4032
    v_pk_mul_f32 v[180:181], v[176:177], v[154:155] op_sel:[0,0] op_sel_hi:[1,0]
    v_pk_fma_f32 v[176:177], v[176:177], v[154:155], v[180:181] op_sel:[1,1,0] op_sel_hi:[0,1,1] neg_lo:[0,1,0]
    v_cvt_pk_bf16_f32 v79, v176, v177
    ds_write_addtid_b32 v79 offset:4320
    ds_read_b128 v[64:67], v239 offset:0
    ds_read_b128 v[68:71], v239 offset:64
    ds_read_b128 v[72:75], v239 offset:128
    ds_read_b128 v[76:79], v239 offset:192
    v_exp_f32 v144, v144
    v_cos_f32 v152, v145
    v_sin_f32 v153, v145
    s_waitcnt lgkmcnt(15)
    v_pk_mul_f32 v[160:161], v[148:149], v[146:147] op_sel:[0,0] op_sel_hi:[1,0]
    v_pk_fma_f32 v[160:161], v[148:149], v[146:147], v[160:161] op_sel:[1,1,0] op_sel_hi:[0,1,1] neg_lo:[0,1,0]
    v_pk_mul_f32 v[152:153], v[152:153], v[144:145] op_sel_hi:[1,0]
    v_pk_mul_f32 v[160:161], v[160:161], v[44:45] op_sel_hi:[1,0]
    v_pk_mul_f32 v[180:181], v[176:177], v[154:155] op_sel:[0,0] op_sel_hi:[1,0]
    v_pk_fma_f32 v[176:177], v[176:177], v[154:155], v[180:181] op_sel:[1,1,0] op_sel_hi:[0,1,1] neg_lo:[0,1,0]
    s_setprio 1
    v_cvt_pk_bf16_f32 v80, v160, v161
    s_waitcnt lgkmcnt(15)
    s_barrier
    s_setprio 3
    ds_read_b64_tr_b16 v[108:109], v237
    ds_read_b64_tr_b16 v[110:111], v237 offset:4352
    buffer_store_dwordx4 v[48:51], v1, s[56:59], s61 offen sc1
    ds_write_addtid_b32 v80 offset:0
    v_pk_mul_f32 v[162:163], v[160:161], v[152:153] op_sel:[0,0] op_sel_hi:[1,0]
    v_pk_fma_f32 v[162:163], v[160:161], v[152:153], v[162:163] op_sel:[1,1,0] op_sel_hi:[0,1,1] neg_lo:[0,1,0]
    v_cvt_pk_bf16_f32 v81, v162, v163
    ds_write_addtid_b32 v81 offset:288
    v_pk_mul_f32 v[164:165], v[162:163], v[152:153] op_sel:[0,0] op_sel_hi:[1,0]
    v_pk_fma_f32 v[164:165], v[162:163], v[152:153], v[164:165] op_sel:[1,1,0] op_sel_hi:[0,1,1] neg_lo:[0,1,0]
    v_cvt_pk_bf16_f32 v82, v164, v165
    ds_write_addtid_b32 v82 offset:576
    v_pk_mul_f32 v[166:167], v[164:165], v[152:153] op_sel:[0,0] op_sel_hi:[1,0]
    v_pk_fma_f32 v[166:167], v[164:165], v[152:153], v[166:167] op_sel:[1,1,0] op_sel_hi:[0,1,1] neg_lo:[0,1,0]
    v_cvt_pk_bf16_f32 v83, v166, v167
    s_waitcnt lgkmcnt(3)
    s_nop 0
    buffer_store_dwordx4 v[108:111], v238, s[52:55], s60 offen sc1
    s_mov_b32 s54, 16777216
    ds_write_addtid_b32 v83 offset:864
    v_pk_mul_f32 v[168:169], v[166:167], v[152:153] op_sel:[0,0] op_sel_hi:[1,0]
    v_pk_fma_f32 v[168:169], v[166:167], v[152:153], v[168:169] op_sel:[1,1,0] op_sel_hi:[0,1,1] neg_lo:[0,1,0]
    v_cvt_pk_bf16_f32 v84, v168, v169
    ds_write_addtid_b32 v84 offset:1152
    v_pk_mul_f32 v[170:171], v[168:169], v[152:153] op_sel:[0,0] op_sel_hi:[1,0]
    v_pk_fma_f32 v[170:171], v[168:169], v[152:153], v[170:171] op_sel:[1,1,0] op_sel_hi:[0,1,1] neg_lo:[0,1,0]
    v_cvt_pk_bf16_f32 v85, v170, v171
    ds_write_addtid_b32 v85 offset:1440
    v_pk_mul_f32 v[172:173], v[170:171], v[152:153] op_sel:[0,0] op_sel_hi:[1,0]
    v_pk_fma_f32 v[172:173], v[170:171], v[152:153], v[172:173] op_sel:[1,1,0] op_sel_hi:[0,1,1] neg_lo:[0,1,0]
    v_cvt_pk_bf16_f32 v86, v172, v173
    ds_write_addtid_b32 v86 offset:1728
    v_pk_mul_f32 v[174:175], v[172:173], v[152:153] op_sel:[0,0] op_sel_hi:[1,0]
    v_pk_fma_f32 v[174:175], v[172:173], v[152:153], v[174:175] op_sel:[1,1,0] op_sel_hi:[0,1,1] neg_lo:[0,1,0]
    v_cvt_pk_bf16_f32 v87, v174, v175
    ds_write_addtid_b32 v87 offset:2016
    s_setprio 0
    s_setprio 2
    v_pk_mul_f32 v[180:181], v[160:161], v[176:177] op_sel:[0,0] op_sel_hi:[1,0]
    v_pk_fma_f32 v[160:161], v[160:161], v[176:177], v[180:181] op_sel:[1,1,0] op_sel_hi:[0,1,1] neg_hi:[0,1,0]
    v_cvt_pk_bf16_f32 v88, v160, v161
    ds_write_addtid_b32 v88 offset:2304
    v_pk_mul_f32 v[180:181], v[162:163], v[176:177] op_sel:[0,0] op_sel_hi:[1,0]
    v_pk_fma_f32 v[162:163], v[162:163], v[176:177], v[180:181] op_sel:[1,1,0] op_sel_hi:[0,1,1] neg_hi:[0,1,0]
    v_cvt_pk_bf16_f32 v89, v162, v163
    ds_write_addtid_b32 v89 offset:2592
    v_pk_mul_f32 v[180:181], v[164:165], v[176:177] op_sel:[0,0] op_sel_hi:[1,0]
    v_pk_fma_f32 v[164:165], v[164:165], v[176:177], v[180:181] op_sel:[1,1,0] op_sel_hi:[0,1,1] neg_hi:[0,1,0]
    v_cvt_pk_bf16_f32 v90, v164, v165
    ds_write_addtid_b32 v90 offset:2880
    v_pk_mul_f32 v[180:181], v[166:167], v[176:177] op_sel:[0,0] op_sel_hi:[1,0]
    v_pk_fma_f32 v[166:167], v[166:167], v[176:177], v[180:181] op_sel:[1,1,0] op_sel_hi:[0,1,1] neg_hi:[0,1,0]
    v_cvt_pk_bf16_f32 v91, v166, v167
    ds_write_addtid_b32 v91 offset:3168
    v_pk_mul_f32 v[180:181], v[168:169], v[176:177] op_sel:[0,0] op_sel_hi:[1,0]
    v_pk_fma_f32 v[168:169], v[168:169], v[176:177], v[180:181] op_sel:[1,1,0] op_sel_hi:[0,1,1] neg_hi:[0,1,0]
    v_cvt_pk_bf16_f32 v92, v168, v169
    ds_write_addtid_b32 v92 offset:3456
    v_pk_mul_f32 v[180:181], v[170:171], v[176:177] op_sel:[0,0] op_sel_hi:[1,0]
    v_pk_fma_f32 v[170:171], v[170:171], v[176:177], v[180:181] op_sel:[1,1,0] op_sel_hi:[0,1,1] neg_hi:[0,1,0]
    v_cvt_pk_bf16_f32 v93, v170, v171
    ds_write_addtid_b32 v93 offset:3744
    v_pk_mul_f32 v[180:181], v[172:173], v[176:177] op_sel:[0,0] op_sel_hi:[1,0]
    v_pk_fma_f32 v[172:173], v[172:173], v[176:177], v[180:181] op_sel:[1,1,0] op_sel_hi:[0,1,1] neg_hi:[0,1,0]
    v_cvt_pk_bf16_f32 v94, v172, v173
    ds_write_addtid_b32 v94 offset:4032
    v_pk_mul_f32 v[180:181], v[174:175], v[176:177] op_sel:[0,0] op_sel_hi:[1,0]
    v_pk_fma_f32 v[174:175], v[174:175], v[176:177], v[180:181] op_sel:[1,1,0] op_sel_hi:[0,1,1] neg_hi:[0,1,0]
    v_cvt_pk_bf16_f32 v95, v174, v175
    ds_write_addtid_b32 v95 offset:4320
    ds_read_b128 v[80:83], v239 offset:0
    ds_read_b128 v[84:87], v239 offset:64
    ds_read_b128 v[88:91], v239 offset:128
    ds_read_b128 v[92:95], v239 offset:192
    s_setprio 1
    s_nop 0
    v_pk_mul_f32 v[180:181], v[160:161], v[176:177] op_sel:[0,0] op_sel_hi:[1,0]
    v_pk_fma_f32 v[160:161], v[160:161], v[176:177], v[180:181] op_sel:[1,1,0] op_sel_hi:[0,1,1] neg_hi:[0,1,0]
    v_cvt_pk_bf16_f32 v112, v160, v161
    ds_write_addtid_b32 v112 offset:0
    v_pk_mul_f32 v[180:181], v[164:165], v[176:177] op_sel:[0,0] op_sel_hi:[1,0]
    v_pk_fma_f32 v[164:165], v[164:165], v[176:177], v[180:181] op_sel:[1,1,0] op_sel_hi:[0,1,1] neg_hi:[0,1,0]
    v_cvt_pk_bf16_f32 v113, v164, v165
    ds_write_addtid_b32 v113 offset:288
    v_pk_mul_f32 v[180:181], v[168:169], v[176:177] op_sel:[0,0] op_sel_hi:[1,0]
    v_pk_fma_f32 v[168:169], v[168:169], v[176:177], v[180:181] op_sel:[1,1,0] op_sel_hi:[0,1,1] neg_hi:[0,1,0]
    v_cvt_pk_bf16_f32 v114, v168, v169
    ds_write_addtid_b32 v114 offset:576
    v_pk_mul_f32 v[180:181], v[172:173], v[176:177] op_sel:[0,0] op_sel_hi:[1,0]
    v_pk_fma_f32 v[172:173], v[172:173], v[176:177], v[180:181] op_sel:[1,1,0] op_sel_hi:[0,1,1] neg_hi:[0,1,0]
    v_cvt_pk_bf16_f32 v115, v172, v173
    ds_write_addtid_b32 v115 offset:864
    v_pk_mul_f32 v[180:181], v[160:161], v[176:177] op_sel:[0,0] op_sel_hi:[1,0]
    v_pk_fma_f32 v[160:161], v[160:161], v[176:177], v[180:181] op_sel:[1,1,0] op_sel_hi:[0,1,1] neg_hi:[0,1,0]
    v_cvt_pk_bf16_f32 v116, v160, v161
    ds_write_addtid_b32 v116 offset:1152
    v_pk_mul_f32 v[180:181], v[164:165], v[176:177] op_sel:[0,0] op_sel_hi:[1,0]
    v_pk_fma_f32 v[164:165], v[164:165], v[176:177], v[180:181] op_sel:[1,1,0] op_sel_hi:[0,1,1] neg_hi:[0,1,0]
    v_cvt_pk_bf16_f32 v117, v164, v165
    ds_write_addtid_b32 v117 offset:1440
    s_setprio 0
    s_nop 0
    v_pk_mul_f32 v[180:181], v[168:169], v[176:177] op_sel:[0,0] op_sel_hi:[1,0]
    v_pk_fma_f32 v[168:169], v[168:169], v[176:177], v[180:181] op_sel:[1,1,0] op_sel_hi:[0,1,1] neg_hi:[0,1,0]
    v_cvt_pk_bf16_f32 v118, v168, v169
    ds_write_addtid_b32 v118 offset:1728
    v_pk_mul_f32 v[180:181], v[172:173], v[176:177] op_sel:[0,0] op_sel_hi:[1,0]
    v_pk_fma_f32 v[172:173], v[172:173], v[176:177], v[180:181] op_sel:[1,1,0] op_sel_hi:[0,1,1] neg_hi:[0,1,0]
    v_cvt_pk_bf16_f32 v119, v172, v173
    ds_write_addtid_b32 v119 offset:2016
    v_pk_mul_f32 v[180:181], v[160:161], v[176:177] op_sel:[0,0] op_sel_hi:[1,0]
    v_pk_fma_f32 v[160:161], v[160:161], v[176:177], v[180:181] op_sel:[1,1,0] op_sel_hi:[0,1,1] neg_hi:[0,1,0]
    v_cvt_pk_bf16_f32 v120, v160, v161
    ds_write_addtid_b32 v120 offset:2304
    v_pk_mul_f32 v[180:181], v[168:169], v[176:177] op_sel:[0,0] op_sel_hi:[1,0]
    v_pk_fma_f32 v[168:169], v[168:169], v[176:177], v[180:181] op_sel:[1,1,0] op_sel_hi:[0,1,1] neg_hi:[0,1,0]
    v_cvt_pk_bf16_f32 v121, v168, v169
    ds_write_addtid_b32 v121 offset:2592
    v_pk_mul_f32 v[180:181], v[160:161], v[176:177] op_sel:[0,0] op_sel_hi:[1,0]
    v_pk_fma_f32 v[160:161], v[160:161], v[176:177], v[180:181] op_sel:[1,1,0] op_sel_hi:[0,1,1] neg_hi:[0,1,0]
    v_cvt_pk_bf16_f32 v122, v160, v161
    ds_write_addtid_b32 v122 offset:2880
    v_pk_mul_f32 v[180:181], v[168:169], v[176:177] op_sel:[0,0] op_sel_hi:[1,0]
    v_pk_fma_f32 v[168:169], v[168:169], v[176:177], v[180:181] op_sel:[1,1,0] op_sel_hi:[0,1,1] neg_hi:[0,1,0]
    v_cvt_pk_bf16_f32 v123, v168, v169
    ds_write_addtid_b32 v123 offset:3168
    v_pk_mul_f32 v[180:181], v[160:161], v[176:177] op_sel:[0,0] op_sel_hi:[1,0]
    v_pk_fma_f32 v[160:161], v[160:161], v[176:177], v[180:181] op_sel:[1,1,0] op_sel_hi:[0,1,1] neg_hi:[0,1,0]
    v_cvt_pk_bf16_f32 v124, v160, v161
    ds_write_addtid_b32 v124 offset:3456
    v_pk_mul_f32 v[180:181], v[168:169], v[176:177] op_sel:[0,0] op_sel_hi:[1,0]
    v_pk_fma_f32 v[168:169], v[168:169], v[176:177], v[180:181] op_sel:[1,1,0] op_sel_hi:[0,1,1] neg_hi:[0,1,0]
    v_cvt_pk_bf16_f32 v125, v168, v169
    ds_write_addtid_b32 v125 offset:3744
    v_pk_mul_f32 v[180:181], v[160:161], v[176:177] op_sel:[0,0] op_sel_hi:[1,0]
    v_pk_fma_f32 v[160:161], v[160:161], v[176:177], v[180:181] op_sel:[1,1,0] op_sel_hi:[0,1,1] neg_hi:[0,1,0]
    v_cvt_pk_bf16_f32 v126, v160, v161
    ds_write_addtid_b32 v126 offset:4032
    v_pk_mul_f32 v[180:181], v[168:169], v[176:177] op_sel:[0,0] op_sel_hi:[1,0]
    v_pk_fma_f32 v[168:169], v[168:169], v[176:177], v[180:181] op_sel:[1,1,0] op_sel_hi:[0,1,1] neg_hi:[0,1,0]
    v_cvt_pk_bf16_f32 v127, v168, v169
    s_waitcnt vmcnt(4)
    s_barrier
    ds_write_addtid_b32 v127 offset:4320
    ds_read_b128 v[112:115], v239 offset:0
    ds_read_b128 v[116:119], v239 offset:64
    ds_read_b128 v[120:123], v239 offset:128
    ds_read_b128 v[124:127], v239 offset:192
    v_pk_mul_f32 v[180:181], v[160:161], v[176:177] op_sel:[0,0] op_sel_hi:[1,0]
    v_pk_fma_f32 v[160:161], v[160:161], v[176:177], v[180:181] op_sel:[1,1,0] op_sel_hi:[0,1,1] neg_hi:[0,1,0]
    v_cvt_pk_bf16_f32 v200, v160, v161
    ds_write_addtid_b32 v200 offset:0
    v_pk_mul_f32 v[180:181], v[160:161], v[176:177] op_sel:[0,0] op_sel_hi:[1,0]
    v_pk_fma_f32 v[160:161], v[160:161], v[176:177], v[180:181] op_sel:[1,1,0] op_sel_hi:[0,1,1] neg_hi:[0,1,0]
    v_cvt_pk_bf16_f32 v201, v160, v161
    ds_write_addtid_b32 v201 offset:288
    v_pk_mul_f32 v[180:181], v[160:161], v[176:177] op_sel:[0,0] op_sel_hi:[1,0]
    v_pk_fma_f32 v[160:161], v[160:161], v[176:177], v[180:181] op_sel:[1,1,0] op_sel_hi:[0,1,1] neg_hi:[0,1,0]
    v_cvt_pk_bf16_f32 v202, v160, v161
    ds_write_addtid_b32 v202 offset:576
    v_pk_mul_f32 v[180:181], v[160:161], v[176:177] op_sel:[0,0] op_sel_hi:[1,0]
    v_pk_fma_f32 v[160:161], v[160:161], v[176:177], v[180:181] op_sel:[1,1,0] op_sel_hi:[0,1,1] neg_hi:[0,1,0]
    v_cvt_pk_bf16_f32 v203, v160, v161
    ds_write_addtid_b32 v203 offset:864
    v_pk_mul_f32 v[180:181], v[160:161], v[176:177] op_sel:[0,0] op_sel_hi:[1,0]
    v_pk_fma_f32 v[160:161], v[160:161], v[176:177], v[180:181] op_sel:[1,1,0] op_sel_hi:[0,1,1] neg_hi:[0,1,0]
    v_cvt_pk_bf16_f32 v204, v160, v161
    ds_write_addtid_b32 v204 offset:1152
    v_pk_mul_f32 v[180:181], v[160:161], v[176:177] op_sel:[0,0] op_sel_hi:[1,0]
    v_pk_fma_f32 v[160:161], v[160:161], v[176:177], v[180:181] op_sel:[1,1,0] op_sel_hi:[0,1,1] neg_hi:[0,1,0]
    v_cvt_pk_bf16_f32 v205, v160, v161
    ds_write_addtid_b32 v205 offset:1440
    v_pk_mul_f32 v[180:181], v[160:161], v[176:177] op_sel:[0,0] op_sel_hi:[1,0]
    v_pk_fma_f32 v[160:161], v[160:161], v[176:177], v[180:181] op_sel:[1,1,0] op_sel_hi:[0,1,1] neg_hi:[0,1,0]
    v_cvt_pk_bf16_f32 v206, v160, v161
    ds_write_addtid_b32 v206 offset:1728
    v_pk_mul_f32 v[180:181], v[160:161], v[176:177] op_sel:[0,0] op_sel_hi:[1,0]
    v_pk_fma_f32 v[160:161], v[160:161], v[176:177], v[180:181] op_sel:[1,1,0] op_sel_hi:[0,1,1] neg_hi:[0,1,0]
    v_cvt_pk_bf16_f32 v207, v160, v161
    ds_write_addtid_b32 v207 offset:2016
    s_add_u32 m0, s81, 16384
    s_add_u32 s79, s79, 114688
    buffer_load_dwordx4 v12, s[40:43], s79 offen lds
    buffer_load_dwordx4 v13, s[44:47], s79 offen offset:1024 lds
    s_mov_b32 m0, s97
    s_nop 0
    v_pk_mul_f32 v[180:181], v[160:161], v[176:177] op_sel:[0,0] op_sel_hi:[1,0]
    v_pk_fma_f32 v[160:161], v[160:161], v[176:177], v[180:181] op_sel:[1,1,0] op_sel_hi:[0,1,1] neg_hi:[0,1,0]
    v_cvt_pk_bf16_f32 v208, v160, v161
    ds_write_addtid_b32 v208 offset:2304
    ds_read_b128 v[200:203], v239 offset:0
    ds_read_b128 v[204:207], v239 offset:64
    ds_read_b128 v[208:211], v239 offset:128
    ds_read_b128 v[212:215], v239 offset:192
    s_setprio 0
    s_waitcnt lgkmcnt(15)
    v_mfma_f32_16x16x32_bf16 v[188:191], v[80:83], v[64:67], 0
    v_mfma_f32_16x16x32_bf16 v[188:191], v[84:87], v[68:71], v[188:191]
    v_mfma_f32_16x16x32_bf16 v[188:191], v[88:91], v[72:75], v[188:191]
    v_mfma_f32_16x16x32_bf16 v[188:191], v[92:95], v[76:79], v[188:191]
    s_waitcnt lgkmcnt(13)
    s_nop 0
    v_mfma_f32_16x16x32_bf16 v[192:195], v[112:115], v[64:67], 0
    v_mfma_f32_16x16x32_bf16 v[192:195], v[116:119], v[68:71], v[192:195]
    v_mfma_f32_16x16x32_bf16 v[192:195], v[120:123], v[72:75], v[192:195]
    v_mfma_f32_16x16x32_bf16 v[192:195], v[124:127], v[76:79], v[192:195]
    s_nop 2
    s_nop 0
    ds_write_b128 v40, v[188:191]
    ds_read_b64_tr_b16 v[96:97], v18 offset:0
    ds_read_b64_tr_b16 v[98:99], v18 offset:2048
    ds_read_b128 v[104:107], v14 offset:0
    ds_read_b128 v[108:111], v14 offset:4096
    ds_read_b64_tr_b16 v[100:101], v19 offset:0
    ds_read_b64_tr_b16 v[102:103], v19 offset:2048
    ds_write_b64 v41, v[192:193] offset:1024
    ds_write_b64 v42, v[194:195] offset:1032
    s_waitcnt lgkmcnt(9)
    s_nop 0
    v_mfma_f32_16x16x32_bf16 v[196:199], v[200:203], v[64:67], 0
    v_mfma_f32_16x16x32_bf16 v[196:199], v[204:207], v[68:71], v[196:199]
    v_mfma_f32_16x16x32_bf16 v[196:199], v[208:211], v[72:75], v[196:199]
    v_mfma_f32_16x16x32_bf16 v[196:199], v[212:215], v[76:79], v[196:199]
    s_waitcnt vmcnt(4)
    v_readfirstlane_b32 s80, v54
    s_add_u32 m0, s81, 81920
    s_add_u32 s78, s78, 128
    buffer_load_dwordx4 v10, s[36:39], s78 offen lds
    buffer_load_dwordx4 v11, s[36:39], s78 offen offset:1024 lds
    s_add_u32 m0, s81, 32768
    s_add_u32 s79, s79, 114688
    buffer_load_dwordx4 v12, s[40:43], s79 offen lds
    buffer_load_dwordx4 v13, s[44:47], s79 offen offset:1024 lds
    s_nop 5
    s_nop 0
    ds_write_b32 v43, v196 offset:2048
    ds_write_b32 v43, v197 offset:2112
    ds_write_b32 v43, v198 offset:2176
    ds_write_b32 v43, v199 offset:2240
    s_waitcnt lgkmcnt(6)
    s_nop 0
    v_mfma_f32_32x32x16_bf16 v[32:47], v[96:99], v[104:107], 0
    ds_read_b64_tr_b16 v[112:113], v18 offset:8192
    ds_read_b64_tr_b16 v[114:115], v18 offset:10240
    ds_read_b128 v[120:123], v15 offset:0
    s_mul_i32 s80, s80, 0x41c64e6d
    s_add_u32 s80, s80, 0x3c6ef35f
    v_mov_b32 v254, s80
    v_lshrrev_b32 v252, 5, v0
    v_mfma_f32_32x32x16_bf16 v[48:63], v[96:99], v[108:111], 0
    ds_read_b128 v[124:127], v15 offset:4096
    ds_read_b64_tr_b16 v[116:117], v19 offset:8192
    ds_read_b64_tr_b16 v[118:119], v19 offset:10240
    s_add_u32 m0, s81, 49152
    s_add_u32 s79, s79, 114688
    buffer_load_dwordx4 v12, s[40:43], s79 offen lds
    v_lshlrev_b32_e64 v252, 23, v252
    v_mfma_f32_32x32x16_bf16 v[64:79], v[100:103], v[104:107], 0
    buffer_load_dwordx4 v13, s[44:47], s79 offen offset:1024 lds
    v_add_lshl_u32 v252, v252, v0, 2
    s_mov_b64 s[48:49], s[28:29]
    s_nop 0
    s_mov_b32 s50, 1605632
    s_mov_b32 s51, 0x20000
    s_mul_i32 s4, s3, 28672
    s_add_u32 s69, s69, s4
    v_mfma_f32_32x32x16_bf16 v[80:95], v[100:103], v[108:111], 0
    s_waitcnt vmcnt(6) lgkmcnt(0)
    s_barrier
    s_nop 0
    v_mfma_f32_32x32x16_bf16 v[32:47], v[112:115], v[120:123], v[32:47]
    ds_read_b64_tr_b16 v[96:97], v18 offset:16384
    ds_read_b64_tr_b16 v[98:99], v18 offset:18432
    ds_read_b128 v[104:107], v16 offset:0
    buffer_store_dword v254, v252, s[52:55], s62 offen sc1
    v_and_b32 v185, 255, v0
    v_mfma_f32_32x32x16_bf16 v[48:63], v[112:115], v[124:127], v[48:63]
    ds_read_b128 v[108:111], v16 offset:4096
    ds_read_b64_tr_b16 v[100:101], v19 offset:16384
    ds_read_b64_tr_b16 v[102:103], v19 offset:18432
    s_mul_i32 s92, s94, 12288
    v_lshlrev_b32_e64 v185, 1, v185
    v_mfma_f32_32x32x16_bf16 v[64:79], v[116:119], v[120:123], v[64:79]
    s_add_u32 m0, s81, 0
    s_nop 0
    s_add_u32 s79, s79, 114688
    buffer_load_dwordx4 v12, s[40:43], s79 offen lds
    s_add_u32 s93, s92, 135168
    v_cvt_f32_u32_e64 v233, v185
    v_mfma_f32_32x32x16_bf16 v[80:95], v[116:119], v[124:127], v[80:95]
    buffer_load_dwordx4 v13, s[44:47], s79 offen offset:1024 lds
    s_add_u32 s92, s92, 67072
    v_add_f32 v224, 0xbf800000, v233
    v_add_f32 v225, 0x0, v233
    v_add_f32 v226, 0x3f800000, v233
    s_waitcnt lgkmcnt(0)
    v_mfma_f32_32x32x16_bf16 v[32:47], v[96:99], v[104:107], v[32:47]
    ds_read_b64_tr_b16 v[112:113], v18 offset:24576
    ds_read_b64_tr_b16 v[114:115], v18 offset:26624
    ds_read_b128 v[120:123], v17 offset:0
    v_cvt_pk_bf16_f32 v225, v224, v225
    v_cvt_pk_bf16_f32 v226, v226, v226
    v_bfe_i32 v224, v225, 0, 16
    v_lshrrev_b32 v225, 16, v225
    v_lshrrev_b32 v226, 16, v226
    v_lshl_add_u32 v224, v224, 2, s92
    v_mfma_f32_32x32x16_bf16 v[48:63], v[96:99], v[108:111], v[48:63]
    ds_read_b128 v[124:127], v17 offset:4096
    ds_read_b64_tr_b16 v[116:117], v19 offset:24576
    ds_read_b64_tr_b16 v[118:119], v19 offset:26624
    s_add_u32 m0, s81, 98304
    s_add_u32 s84, s69, 0
    s_nop 0
    buffer_load_dwordx4 v8, s[48:51], s84 offen lds
    v_lshl_add_u32 v225, v225, 2, s92
    v_lshl_add_u32 v226, v226, 2, s92
    v_add_u32_e64 v186, -1, v185
    v_mfma_f32_32x32x16_bf16 v[64:79], v[100:103], v[104:107], v[64:79]
    buffer_load_dwordx4 v30, s[48:51], s84 offen offset:1024 lds
    v_min_i32 v186, 128, v186
    v_xor_b32 v23, 32, v22
    v_xor_b32 v24, 64, v22
    v_xor_b32 v25, 96, v22
    v_add_u32 v26, 0x10000, v22
    v_add_u32 v27, 0x10000, v23
    v_add_u32 v28, 0x10000, v24
    v_add_u32 v29, 0x10000, v25
    v_mfma_f32_32x32x16_bf16 v[80:95], v[100:103], v[108:111], v[80:95]
    s_waitcnt vmcnt(7) lgkmcnt(0)
    s_barrier
    v_mfma_f32_32x32x16_bf16 v[32:47], v[112:115], v[120:123], v[32:47]
    ds_read_b64_tr_b16 v[96:97], v18 offset:32768
    ds_read_b64_tr_b16 v[98:99], v18 offset:34816
    ds_read_b128 v[104:107], v14 offset:16384
    v_lshl_add_u32 v186, v186, 2, s93
    v_max_i32_e64 v224, v224, v186
    v_mfma_f32_32x32x16_bf16 v[48:63], v[112:115], v[124:127], v[48:63]
    ds_read_b128 v[108:111], v14 offset:20480
    ds_read_b64_tr_b16 v[100:101], v19 offset:32768
    ds_read_b64_tr_b16 v[102:103], v19 offset:34816
    v_add_u32_e64 v186, 0, v185
    v_min_i32 v186, 128, v186
    v_mfma_f32_32x32x16_bf16 v[64:79], v[116:119], v[120:123], v[64:79]
    s_add_u32 m0, s81, 65536
    s_add_u32 s78, s78, 128
    buffer_load_dwordx4 v10, s[36:39], s78 offen lds
    v_lshl_add_u32 v186, v186, 2, s93
    v_max_i32_e64 v225, v225, v186
    v_mfma_f32_32x32x16_bf16 v[80:95], v[116:119], v[124:127], v[80:95]
    buffer_load_dwordx4 v11, s[36:39], s78 offen offset:1024 lds
    v_add_u32_e64 v186, 1, v185
    v_min_i32 v186, 128, v186
    v_lshl_add_u32 v186, v186, 2, s93
    v_max_i32 v226, v226, v186
    s_waitcnt lgkmcnt(0)
    v_mfma_f32_32x32x16_bf16 v[32:47], v[96:99], v[104:107], v[32:47]
    ds_read_b64_tr_b16 v[112:113], v18 offset:40960
    ds_read_b64_tr_b16 v[114:115], v18 offset:43008
    ds_read_b128 v[120:123], v15 offset:16384
    v_add_f32 v227, 0x43ff8000, v233
    v_add_f32 v228, 0x44000000, v233
    v_add_f32 v229, 0x44004000, v233
    v_cvt_pk_bf16_f32 v228, v227, v228
    v_mfma_f32_32x32x16_bf16 v[48:63], v[96:99], v[108:111], v[48:63]
    ds_read_b128 v[124:127], v15 offset:20480
    ds_read_b64_tr_b16 v[116:117], v19 offset:40960
    ds_read_b64_tr_b16 v[118:119], v19 offset:43008
    s_add_u32 m0, s81, 16384
    s_add_u32 s79, s79, 114688
    buffer_load_dwordx4 v12, s[40:43], s79 offen lds
    v_cvt_pk_bf16_f32 v229, v229, v229
    v_mfma_f32_32x32x16_bf16 v[64:79], v[100:103], v[104:107], v[64:79]
    buffer_load_dwordx4 v13, s[44:47], s79 offen offset:1024 lds
    v_bfe_i32 v227, v228, 0, 16
    v_lshrrev_b32_e64 v228, 16, v228
    ds_read2st64_b32 v[200:201], v224 offset0:0 offset1:12
    ds_read2st64_b32 v[202:203], v224 offset0:24 offset1:36
    v_mfma_f32_32x32x16_bf16 v[80:95], v[100:103], v[108:111], v[80:95]
    s_waitcnt vmcnt(9) lgkmcnt(2)
    s_barrier
    v_mfma_f32_32x32x16_bf16 v[32:47], v[112:115], v[120:123], v[32:47]
    ds_read_b64_tr_b16 v[96:97], v18 offset:49152
    ds_read_b64_tr_b16 v[98:99], v18 offset:51200
    ds_read_b128 v[104:107], v16 offset:16384
    v_lshrrev_b32_e64 v229, 16, v229
    v_lshl_add_u32 v227, v227, 2, s92
    v_lshl_add_u32 v228, v228, 2, s92
    v_mfma_f32_32x32x16_bf16 v[48:63], v[112:115], v[124:127], v[48:63]
    ds_read_b128 v[108:111], v16 offset:20480
    ds_read_b64_tr_b16 v[100:101], v19 offset:49152
    ds_read_b64_tr_b16 v[102:103], v19 offset:51200
    s_add_u32 m0, s81, 32768
    s_add_u32 s79, s79, 114688
    buffer_load_dwordx4 v12, s[40:43], s79 offen lds
    v_mfma_f32_32x32x16_bf16 v[64:79], v[116:119], v[120:123], v[64:79]
    buffer_load_dwordx4 v13, s[44:47], s79 offen offset:1024 lds
    v_lshl_add_u32 v229, v229, 2, s92
    v_add_f32 v230, 0x447fc000, v233
    v_add_f32 v231, 0x44800000, v233
    v_add_f32 v232, 0x44802000, v233
    ds_read2st64_b32 v[204:205], v225 offset0:0 offset1:12
    v_mfma_f32_32x32x16_bf16 v[80:95], v[116:119], v[124:127], v[80:95]
    s_waitcnt vmcnt(6)
    s_nop 0
    ds_read_b64_tr_b16 v[144:145], v26 offset:32768
    ds_read_b64_tr_b16 v[148:149], v27 offset:32768
    ds_read_b64_tr_b16 v[152:153], v28 offset:32768
    ds_read_b64_tr_b16 v[156:157], v29 offset:32768
    ds_read2st64_b32 v[206:207], v225 offset0:24 offset1:36
    s_waitcnt lgkmcnt(6)
    s_nop 0
    v_mfma_f32_32x32x16_bf16 v[32:47], v[96:99], v[104:107], v[32:47]
    ds_read_b64_tr_b16 v[112:113], v18 offset:57344
    ds_read_b64_tr_b16 v[114:115], v18 offset:59392
    ds_read_b128 v[120:123], v17 offset:16384
    v_cvt_pk_bf16_f32 v231, v230, v231
    v_cvt_pk_bf16_f32 v232, v232, v232
    v_bfe_i32 v230, v231, 0, 16
    v_lshrrev_b32_e64 v231, 16, v231
    v_mfma_f32_32x32x16_bf16 v[48:63], v[96:99], v[108:111], v[48:63]
    ds_read_b128 v[124:127], v17 offset:20480
    ds_read_b64_tr_b16 v[116:117], v19 offset:57344
    ds_read_b64_tr_b16 v[118:119], v19 offset:59392
    s_waitcnt lgkmcnt(7)
    s_nop 0
    s_add_u32 m0, s81, 98304
    s_add_u32 s84, s69, 7168
    buffer_load_dwordx4 v8, s[48:51], s84 offen lds
    v_mfma_f32_32x32x16_bf16 v[64:79], v[100:103], v[104:107], v[64:79]
    buffer_load_dwordx4 v30, s[48:51], s84 offen offset:1024 lds
    v_lshrrev_b32_e64 v232, 16, v232
    v_lshl_add_u32 v230, v230, 2, s92
    v_lshl_add_u32 v231, v231, 2, s92
    v_lshl_add_u32 v232, v232, 2, s92
    ds_read2st64_b32 v[208:209], v226 offset0:0 offset1:12
    ds_read2st64_b32 v[210:211], v226 offset0:24 offset1:36
    v_mfma_f32_32x32x16_bf16 v[80:95], v[100:103], v[108:111], v[80:95]
    s_waitcnt vmcnt(6) lgkmcnt(2)
    s_barrier
    v_mfma_f32_32x32x16_bf16 v[32:47], v[112:115], v[120:123], v[32:47]
    ds_read_b64_tr_b16 v[96:97], v18 offset:0
    ds_read_b64_tr_b16 v[98:99], v18 offset:2048
    ds_read_b128 v[104:107], v14 offset:0
    s_mov_b64 s[56:57], s[30:31]
    s_nop 0
    v_mfma_f32_32x32x16_bf16 v[48:63], v[112:115], v[124:127], v[48:63]
    ds_read_b128 v[108:111], v14 offset:4096
    ds_read_b64_tr_b16 v[100:101], v19 offset:0
    ds_read_b64_tr_b16 v[102:103], v19 offset:2048
    s_mov_b32 s58, 1835008
    v_mfma_f32_32x32x16_bf16 v[64:79], v[116:119], v[120:123], v[64:79]
    s_add_u32 m0, s81, 81920
    s_add_u32 s78, s78, 128
    buffer_load_dwordx4 v10, s[36:39], s78 offen lds
    s_mul_i32 s4, s3, 14336
    v_mfma_f32_32x32x16_bf16 v[80:95], v[116:119], v[124:127], v[80:95]
    buffer_load_dwordx4 v11, s[36:39], s78 offen offset:1024 lds
    ds_read2st64_b32 v[212:213], v227 offset0:0 offset1:12
    ds_read2st64_b32 v[214:215], v227 offset0:24 offset1:36
    s_waitcnt lgkmcnt(2)
    s_nop 0
    v_mfma_f32_32x32x16_bf16 v[32:47], v[96:99], v[104:107], v[32:47]
    ds_read_b64_tr_b16 v[112:113], v18 offset:8192
    ds_read_b64_tr_b16 v[114:115], v18 offset:10240
    ds_read_b128 v[120:123], v15 offset:0
    v_cmp_eq_u32 vcc, 0, v185
    s_waitcnt lgkmcnt(11)
    v_add_f32 v200, v200, v201
    v_add_f32 v202, v202, v203
    v_add_f32_e64 v204, v204, v205
    v_mfma_f32_32x32x16_bf16 v[48:63], v[96:99], v[108:111], v[48:63]
    ds_read_b128 v[124:127], v15 offset:4096
    ds_read_b64_tr_b16 v[116:117], v19 offset:8192
    ds_read_b64_tr_b16 v[118:119], v19 offset:10240
    s_add_u32 m0, s81, 49152
    s_add_u32 s79, s79, 114688
    buffer_load_dwordx4 v12, s[40:43], s79 offen lds
    v_add_f32 v206, v206, v207
    v_add_f32 v208, v208, v209
    v_mfma_f32_32x32x16_bf16 v[64:79], v[100:103], v[104:107], v[64:79]
    buffer_load_dwordx4 v13, s[44:47], s79 offen offset:1024 lds
    v_add_f32_e64 v210, v210, v211
    s_add_u32 s4, s4, s65
    s_cmp_ge_u32 s3, 1
    s_cselect_b32 s64, s4, s64
    s_cmp_ge_u32 s3, 3
    s_cselect_b32 s64, 1073741824, s64
    s_min_u32 s65, s3, 3
    ds_read2st64_b32 v[216:217], v228 offset0:0 offset1:12
    ds_read2st64_b32 v[218:219], v228 offset0:24 offset1:36
    v_mfma_f32_32x32x16_bf16 v[80:95], v[100:103], v[108:111], v[80:95]
    s_waitcnt vmcnt(8) lgkmcnt(2)
    s_barrier
    v_mfma_f32_32x32x16_bf16 v[32:47], v[112:115], v[120:123], v[32:47]
    ds_read_b64_tr_b16 v[96:97], v18 offset:16384
    ds_read_b64_tr_b16 v[98:99], v18 offset:18432
    ds_read_b128 v[104:107], v16 offset:0
    v_cndmask_b32 v184, 0, v184, vcc
    v_add_f32 v200, v200, v202
    v_add_f32 v204, v204, v206
    v_add_f32 v208, v208, v210
    v_add_f32_e64 v204, v204, v184
    v_mfma_f32_32x32x16_bf16 v[48:63], v[112:115], v[124:127], v[48:63]
    ds_read_b128 v[108:111], v16 offset:4096
    ds_read_b64_tr_b16 v[100:101], v19 offset:16384
    ds_read_b64_tr_b16 v[102:103], v19 offset:18432
    s_add_u32 m0, s81, 0
    s_add_u32 s79, s79, 114688
    buffer_load_dwordx4 v12, s[40:43], s79 offen lds
    v_cndmask_b32 v200, v200, v255, vcc
    v_cvt_pk_bf16_f32 v240, v200, v204
    v_mfma_f32_32x32x16_bf16 v[64:79], v[116:119], v[120:123], v[64:79]
    buffer_load_dwordx4 v13, s[44:47], s79 offen offset:1024 lds
    v_cvt_pk_bf16_f32 v241, v204, v208
    s_lshl_b32 s65, s65, 10
    s_min_u32 s4, s3, 1
    s_lshl_b32 s4, s4, 30
    s_add_u32 s71, s71, s4
    ds_read2st64_b32 v[220:221], v229 offset0:0 offset1:12
    ds_read2st64_b32 v[222:223], v229 offset0:24 offset1:36
    v_mfma_f32_32x32x16_bf16 v[80:95], v[116:119], v[124:127], v[80:95]
    s_waitcnt vmcnt(6)
    s_nop 0
    ds_read_b64_tr_b16 v[146:147], v26 offset:32768
    ds_read_b64_tr_b16 v[150:151], v27 offset:32768
    ds_read_b64_tr_b16 v[154:155], v28 offset:32768
    ds_read_b64_tr_b16 v[158:159], v29 offset:32768
    s_waitcnt lgkmcnt(6)
    s_nop 0
    v_mfma_f32_32x32x16_bf16 v[32:47], v[96:99], v[104:107], v[32:47]
    ds_read_b64_tr_b16 v[112:113], v18 offset:24576
    ds_read_b64_tr_b16 v[114:115], v18 offset:26624
    ds_read_b128 v[120:123], v17 offset:0
    s_lshl_b32 s4, s94, 6
    s_add_u32 s4, s4, s95
    s_lshl_b32 s4, s4, 7
    s_nop 0
    v_mfma_f32_32x32x16_bf16 v[48:63], v[96:99], v[108:111], v[48:63]
    ds_read_b128 v[124:127], v17 offset:4096
    ds_read_b64_tr_b16 v[116:117], v19 offset:24576
    ds_read_b64_tr_b16 v[118:119], v19 offset:26624
    s_waitcnt lgkmcnt(6)
    s_nop 0
    s_add_u32 m0, s81, 98304
    s_add_u32 s84, s69, 229376
    buffer_load_dwordx4 v8, s[48:51], s84 offen lds
    v_mfma_f32_32x32x16_bf16 v[64:79], v[100:103], v[104:107], v[64:79]
    buffer_load_dwordx4 v30, s[48:51], s84 offen offset:1024 lds
    ds_read2st64_b32 v[200:201], v230 offset0:0 offset1:12
    ds_read2st64_b32 v[202:203], v230 offset0:24 offset1:36
    v_mfma_f32_32x32x16_bf16 v[80:95], v[100:103], v[108:111], v[80:95]
    s_waitcnt vmcnt(6) lgkmcnt(2)
    s_barrier
    v_mfma_f32_32x32x16_bf16 v[32:47], v[112:115], v[120:123], v[32:47]
    ds_read_b64_tr_b16 v[96:97], v18 offset:32768
    ds_read_b64_tr_b16 v[98:99], v18 offset:34816
    ds_read_b128 v[104:107], v14 offset:16384
    s_waitcnt lgkmcnt(15)
    v_add_f32 v212, v212, v213
    v_add_f32_e64 v214, v214, v215
    v_mfma_f32_32x32x16_bf16 v[48:63], v[112:115], v[124:127], v[48:63]
    ds_read_b128 v[108:111], v14 offset:20480
    ds_read_b64_tr_b16 v[100:101], v19 offset:32768
    ds_read_b64_tr_b16 v[102:103], v19 offset:34816
    v_add_f32 v216, v216, v217
    v_add_f32 v218, v218, v219
    v_add_f32_e64 v220, v220, v221
    v_mfma_f32_32x32x16_bf16 v[64:79], v[116:119], v[120:123], v[64:79]
    s_add_u32 m0, s81, 65536
    s_add_u32 s78, s78, 128
    buffer_load_dwordx4 v10, s[36:39], s78 offen lds
    s_add_u32 s68, s68, s4
    s_lshl4_add_u32 s4, s94, s95
    s_lshl_b32 s4, s4, 10
    v_mfma_f32_32x32x16_bf16 v[80:95], v[116:119], v[124:127], v[80:95]
    buffer_load_dwordx4 v11, s[36:39], s78 offen offset:1024 lds
    s_add_u32 s67, s67, s4
    ds_read2st64_b32 v[204:205], v231 offset0:0 offset1:12
    ds_read2st64_b32 v[206:207], v231 offset0:24 offset1:36
    s_waitcnt lgkmcnt(2)
    s_nop 0
    v_mfma_f32_32x32x16_bf16 v[32:47], v[96:99], v[104:107], v[32:47]
    ds_read_b64_tr_b16 v[112:113], v18 offset:40960
    ds_read_b64_tr_b16 v[114:115], v18 offset:43008
    ds_read_b128 v[120:123], v15 offset:16384
    v_add_f32 v222, v222, v223
    v_add_f32 v212, v212, v214
    v_add_f32 v216, v216, v218
    v_add_f32 v220, v220, v222
    v_cvt_pk_bf16_f32 v242, v212, v216
    v_mfma_f32_32x32x16_bf16 v[48:63], v[96:99], v[108:111], v[48:63]
    ds_read_b128 v[124:127], v15 offset:20480
    ds_read_b64_tr_b16 v[116:117], v19 offset:40960
    ds_read_b64_tr_b16 v[118:119], v19 offset:43008
    s_add_u32 m0, s81, 16384
    s_add_u32 s79, s79, 114688
    buffer_load_dwordx4 v12, s[40:43], s79 offen lds
    v_cvt_pk_bf16_f32 v243, v216, v220
    s_add_u32 s70, s70, s4
    v_mfma_f32_32x32x16_bf16 v[64:79], v[100:103], v[104:107], v[64:79]
    buffer_load_dwordx4 v13, s[44:47], s79 offen offset:1024 lds
    s_lshl_b32 s4, s94, 14
    s_add_u32 s70, s70, s4
    s_nop 0
    s_add_u32 s22, s67, 8192
    ds_read2st64_b32 v[208:209], v232 offset0:0 offset1:12
    ds_read2st64_b32 v[210:211], v232 offset0:24 offset1:36
    v_mfma_f32_32x32x16_bf16 v[80:95], v[100:103], v[108:111], v[80:95]
    s_waitcnt vmcnt(8) lgkmcnt(2)
    s_barrier
    v_mfma_f32_32x32x16_bf16 v[32:47], v[112:115], v[120:123], v[32:47]
    ds_read_b64_tr_b16 v[96:97], v18 offset:49152
    ds_read_b64_tr_b16 v[98:99], v18 offset:51200
    ds_read_b128 v[104:107], v16 offset:16384
    v_mov_b32 v138, 0
    v_mov_b32 v139, 0
    v_mov_b32_e64 v142, 0
    v_mfma_f32_32x32x16_bf16 v[48:63], v[112:115], v[124:127], v[48:63]
    ds_read_b128 v[108:111], v16 offset:20480
    ds_read_b64_tr_b16 v[100:101], v19 offset:49152
    ds_read_b64_tr_b16 v[102:103], v19 offset:51200
    s_add_u32 m0, s81, 32768
    s_add_u32 s79, s79, 114688
    buffer_load_dwordx4 v12, s[40:43], s79 offen lds
    v_mfma_f32_32x32x16_bf16 v[64:79], v[116:119], v[120:123], v[64:79]
    buffer_load_dwordx4 v13, s[44:47], s79 offen offset:1024 lds
    v_mov_b32_e64 v143, 0
    ds_read2st64_b32 v[212:213], v230 offset0:1 offset1:13
    ds_read2st64_b32 v[214:215], v230 offset0:25 offset1:37
    v_mfma_f32_32x32x16_bf16 v[80:95], v[116:119], v[124:127], v[80:95]
    s_waitcnt vmcnt(6)
    s_nop 0
    ds_read_b64_tr_b16 v[160:161], v26 offset:32768
    ds_read_b64_tr_b16 v[164:165], v27 offset:32768
    ds_read_b64_tr_b16 v[168:169], v28 offset:32768
    ds_read_b64_tr_b16 v[172:173], v29 offset:32768
    s_waitcnt lgkmcnt(6)
    s_nop 0
    v_mfma_f32_32x32x16_bf16 v[32:47], v[96:99], v[104:107], v[32:47]
    ds_read_b64_tr_b16 v[112:113], v18 offset:57344
    ds_read_b64_tr_b16 v[114:115], v18 offset:59392
    ds_read_b128 v[120:123], v17 offset:16384
    s_waitcnt lgkmcnt(15)
    v_add_f32 v200, v200, v201
    v_add_f32 v202, v202, v203
    v_add_f32 v204, v204, v205
    v_add_f32 v206, v206, v207
    v_add_f32 v208, v208, v209
    v_mov_b32_e64 v130, 0
    v_mfma_f32_32x32x16_bf16 v[48:63], v[96:99], v[108:111], v[48:63]
    ds_read_b128 v[124:127], v17 offset:20480
    ds_read_b64_tr_b16 v[116:117], v19 offset:57344
    ds_read_b64_tr_b16 v[118:119], v19 offset:59392
    s_waitcnt lgkmcnt(6)
    s_nop 0
    s_add_u32 m0, s81, 98304
    s_add_u32 s84, s69, 236544
    buffer_load_dwordx4 v8, s[48:51], s84 offen lds
    v_mov_b32 v131, 0
    v_mov_b32 v134, 0
    v_mov_b32_e64 v135, 0
    v_mfma_f32_32x32x16_bf16 v[64:79], v[100:103], v[104:107], v[64:79]
    buffer_load_dwordx4 v30, s[48:51], s84 offen offset:1024 lds
    ds_read2st64_b32 v[216:217], v231 offset0:1 offset1:13
    ds_read2st64_b32 v[218:219], v231 offset0:25 offset1:37
    v_min_u32 v253, 2, v0
    v_lshrrev_b32 v186, 6, v0
    v_lshl_add_u32 v253, v253, 7, s75
    v_writelane_b32 v253, s63, 0
    v_lshl_add_u32 v253, v186, 27, v253
    v_mfma_f32_32x32x16_bf16 v[80:95], v[100:103], v[108:111], v[80:95]
    s_waitcnt vmcnt(6) lgkmcnt(2)
    s_barrier
    v_mfma_f32_32x32x16_bf16 v[32:47], v[112:115], v[120:123], v[32:47]
    ds_read_b64_tr_b16 v[96:97], v18 offset:0
    ds_read_b64_tr_b16 v[98:99], v18 offset:2048
    ds_read_b128 v[104:107], v14 offset:0
    v_add_f32 v210, v210, v211
    v_add_f32 v200, v200, v202
    v_mfma_f32_32x32x16_bf16 v[48:63], v[112:115], v[124:127], v[48:63]
    ds_read_b128 v[108:111], v14 offset:4096
    ds_read_b64_tr_b16 v[100:101], v19 offset:0
    ds_read_b64_tr_b16 v[102:103], v19 offset:2048
    v_add_f32 v204, v204, v206
    v_add_f32 v208, v208, v210
    v_mfma_f32_32x32x16_bf16 v[64:79], v[116:119], v[120:123], v[64:79]
    s_add_u32 m0, s81, 81920
    s_add_u32 s78, s78, 128
    buffer_load_dwordx4 v10, s[36:39], s78 offen lds
    v_cvt_pk_bf16_f32 v244, v200, v204
    v_cvt_pk_bf16_f32 v245, v204, v208
    v_mfma_f32_32x32x16_bf16 v[80:95], v[116:119], v[124:127], v[80:95]
    buffer_load_dwordx4 v11, s[36:39], s78 offen offset:1024 lds
    ds_read2st64_b32 v[220:221], v232 offset0:1 offset1:13
    ds_read2st64_b32 v[222:223], v232 offset0:25 offset1:37
    s_waitcnt lgkmcnt(2)
    s_nop 0
    v_mfma_f32_32x32x16_bf16 v[32:47], v[96:99], v[104:107], v[32:47]
    ds_read_b64_tr_b16 v[112:113], v18 offset:8192
    ds_read_b64_tr_b16 v[114:115], v18 offset:10240
    ds_read_b128 v[120:123], v15 offset:0
    v_mfma_f32_32x32x16_bf16 v[48:63], v[96:99], v[108:111], v[48:63]
    ds_read_b128 v[124:127], v15 offset:4096
    ds_read_b64_tr_b16 v[116:117], v19 offset:8192
    ds_read_b64_tr_b16 v[118:119], v19 offset:10240
    s_add_u32 m0, s81, 49152
    s_add_u32 s79, s79, 114688
    buffer_load_dwordx4 v12, s[40:43], s79 offen lds
    v_mfma_f32_32x32x16_bf16 v[64:79], v[100:103], v[104:107], v[64:79]
    buffer_load_dwordx4 v13, s[44:47], s79 offen offset:1024 lds
    v_mfma_f32_32x32x16_bf16 v[80:95], v[100:103], v[108:111], v[80:95]
    s_waitcnt vmcnt(8) lgkmcnt(0)
    s_barrier
    v_mfma_f32_32x32x16_bf16 v[32:47], v[112:115], v[120:123], v[32:47]
    ds_read_b64_tr_b16 v[96:97], v18 offset:16384
    ds_read_b64_tr_b16 v[98:99], v18 offset:18432
    ds_read_b128 v[104:107], v16 offset:0
    s_waitcnt lgkmcnt(9)
    v_add_f32 v212, v212, v213
    v_add_f32_e64 v214, v214, v215
    v_mfma_f32_32x32x16_bf16 v[48:63], v[112:115], v[124:127], v[48:63]
    ds_read_b128 v[108:111], v16 offset:4096
    ds_read_b64_tr_b16 v[100:101], v19 offset:16384
    ds_read_b64_tr_b16 v[102:103], v19 offset:18432
    s_add_u32 m0, s81, 0
    s_nop 0
    s_add_u32 s79, s79, 114688
    buffer_load_dwordx4 v12, s[40:43], s79 offen lds
    v_mfma_f32_32x32x16_bf16 v[64:79], v[116:119], v[120:123], v[64:79]
    buffer_load_dwordx4 v13, s[44:47], s79 offen offset:1024 lds
    v_add_f32 v216, v216, v217
    v_add_f32 v218, v218, v219
    v_add_f32_e64 v220, v220, v221
    v_mfma_f32_32x32x16_bf16 v[80:95], v[116:119], v[124:127], v[80:95]
    s_waitcnt vmcnt(6)
    s_nop 0
    ds_read_b64_tr_b16 v[162:163], v26 offset:32768
    ds_read_b64_tr_b16 v[166:167], v27 offset:32768
    ds_read_b64_tr_b16 v[170:171], v28 offset:32768
    ds_read_b64_tr_b16 v[174:175], v29 offset:32768
    s_waitcnt lgkmcnt(4)
    s_nop 0
    v_mfma_f32_32x32x16_bf16 v[32:47], v[96:99], v[104:107], v[32:47]
    ds_read_b64_tr_b16 v[112:113], v18 offset:24576
    ds_read_b64_tr_b16 v[114:115], v18 offset:26624
    ds_read_b128 v[120:123], v17 offset:0
    v_add_f32 v222, v222, v223
    v_add_f32 v212, v212, v214
    v_add_f32_e64 v216, v216, v218
    v_mfma_f32_32x32x16_bf16 v[48:63], v[96:99], v[108:111], v[48:63]
    ds_read_b128 v[124:127], v17 offset:4096
    ds_read_b64_tr_b16 v[116:117], v19 offset:24576
    ds_read_b64_tr_b16 v[118:119], v19 offset:26624
    s_waitcnt lgkmcnt(6)
    s_nop 0
    s_add_u32 m0, s81, 98304
    s_add_u32 s84, s69, 458752
    buffer_load_dwordx4 v8, s[48:51], s84 offen lds
    v_mfma_f32_32x32x16_bf16 v[64:79], v[100:103], v[104:107], v[64:79]
    buffer_load_dwordx4 v30, s[48:51], s84 offen offset:1024 lds
    v_add_f32_e64 v220, v220, v222
    v_cvt_pk_bf16_f32 v246, v212, v216
    v_cvt_pk_bf16_f32 v247, v216, v220
    v_mfma_f32_32x32x16_bf16 v[80:95], v[100:103], v[108:111], v[80:95]
    s_waitcnt vmcnt(6) lgkmcnt(0)
    s_barrier
    v_mfma_f32_32x32x16_bf16 v[32:47], v[112:115], v[120:123], v[32:47]
    ds_read_b64_tr_b16 v[96:97], v18 offset:32768
    ds_read_b64_tr_b16 v[98:99], v18 offset:34816
    ds_read_b128 v[104:107], v14 offset:16384
    v_mfma_f32_32x32x16_bf16 v[48:63], v[112:115], v[124:127], v[48:63]
    ds_read_b128 v[108:111], v14 offset:20480
    ds_read_b64_tr_b16 v[100:101], v19 offset:32768
    ds_read_b64_tr_b16 v[102:103], v19 offset:34816
    buffer_load_dword v236, v253, s[52:55], 0 offen sc1
    v_mfma_f32_32x32x16_bf16 v[64:79], v[116:119], v[120:123], v[64:79]
    s_add_u32 m0, s81, 65536
    s_add_u32 s78, s78, 128
    buffer_load_dwordx4 v10, s[36:39], s78 offen lds
    v_mfma_f32_32x32x16_bf16 v[80:95], v[116:119], v[124:127], v[80:95]
    buffer_load_dwordx4 v11, s[36:39], s78 offen offset:1024 lds
    s_waitcnt lgkmcnt(0)
    s_nop 0
    v_mfma_f32_32x32x16_bf16 v[32:47], v[96:99], v[104:107], v[32:47]
    ds_read_b64_tr_b16 v[112:113], v18 offset:40960
    ds_read_b64_tr_b16 v[114:115], v18 offset:43008
    ds_read_b128 v[120:123], v15 offset:16384
    v_mfma_f32_32x32x16_bf16 v[48:63], v[96:99], v[108:111], v[48:63]
    ds_read_b128 v[124:127], v15 offset:20480
    ds_read_b64_tr_b16 v[116:117], v19 offset:40960
    ds_read_b64_tr_b16 v[118:119], v19 offset:43008
    s_add_u32 m0, s81, 16384
    s_add_u32 s79, s79, 114688
    buffer_load_dwordx4 v12, s[40:43], s79 offen lds
    v_mfma_f32_32x32x16_bf16 v[64:79], v[100:103], v[104:107], v[64:79]
    buffer_load_dwordx4 v13, s[44:47], s79 offen offset:1024 lds
    v_mfma_f32_32x32x16_bf16 v[80:95], v[100:103], v[108:111], v[80:95]
    s_waitcnt vmcnt(9) lgkmcnt(0)
    s_barrier
    v_mfma_f32_32x32x16_bf16 v[32:47], v[112:115], v[120:123], v[32:47]
    ds_read_b64_tr_b16 v[96:97], v18 offset:49152
    ds_read_b64_tr_b16 v[98:99], v18 offset:51200
    ds_read_b128 v[104:107], v16 offset:16384
    v_mfma_f32_32x32x16_bf16 v[48:63], v[112:115], v[124:127], v[48:63]
    ds_read_b128 v[108:111], v16 offset:20480
    ds_read_b64_tr_b16 v[100:101], v19 offset:49152
    ds_read_b64_tr_b16 v[102:103], v19 offset:51200
    v_mfma_f32_32x32x16_bf16 v[64:79], v[116:119], v[120:123], v[64:79]
    s_waitcnt vmcnt(5)
    s_nop 0
    ds_read_b64_tr_b16 v[176:177], v26 offset:32768
    ds_read_b64_tr_b16 v[180:181], v27 offset:32768
    ds_read_b64_tr_b16 v[184:185], v28 offset:32768
    ds_read_b64_tr_b16 v[188:189], v29 offset:32768
    s_add_u32 m0, s81, 123008
    s_add_u32 s84, s69, 917504
    buffer_load_dwordx4 v8, s[48:51], s84 offen lds
    v_mfma_f32_32x32x16_bf16 v[80:95], v[116:119], v[124:127], v[80:95]
    buffer_load_dwordx4 v30, s[48:51], s84 offen offset:1024 lds
    s_waitcnt lgkmcnt(4)
    s_nop 0
    v_mfma_f32_32x32x16_bf16 v[32:47], v[96:99], v[104:107], v[32:47]
    ds_read_b64_tr_b16 v[112:113], v18 offset:57344
    ds_read_b64_tr_b16 v[114:115], v18 offset:59392
    ds_read_b128 v[120:123], v17 offset:16384
    v_and_b32 v250, 0xf0, v9
    v_and_b32_e64 v186, 16, v0
    v_lshl_add_u32 v250, v186, 8, v250
    v_mfma_f32_32x32x16_bf16 v[48:63], v[96:99], v[108:111], v[48:63]
    ds_read_b128 v[124:127], v17 offset:20480
    ds_read_b64_tr_b16 v[116:117], v19 offset:57344
    ds_read_b64_tr_b16 v[118:119], v19 offset:59392
    s_waitcnt lgkmcnt(6)
    s_nop 0
    s_add_u32 m0, s81, 98304
    s_add_u32 s84, s69, 688128
    buffer_load_dwordx4 v8, s[48:51], s84 offen lds
    v_mfma_f32_32x32x16_bf16 v[64:79], v[100:103], v[104:107], v[64:79]
    buffer_load_dwordx4 v30, s[48:51], s84 offen offset:1024 lds
    v_and_b32_e64 v186, 32, v0
    v_lshl_add_u32 v250, v186, 3, v250
    v_and_b32 v11, 32, v0
    v_lshrrev_b32 v11, 2, v11
    v_mfma_f32_32x32x16_bf16 v[80:95], v[100:103], v[108:111], v[80:95]
    s_waitcnt vmcnt(6) lgkmcnt(0)
    s_cmp_lg_u32 s3, 0
    s_cbranch_scc1 L_ok_1
    v_cmp_ne_u32 vcc, s80, v236
    s_cmp_eq_u64 vcc, 0
    s_cbranch_scc1 L_ok_1
    s_mov_b64 exec, vcc
    s_mov_b32 s85, 0
L_poll_2:
    buffer_load_dword v236, v253, s[52:55], 0 offen offset:0 sc1
    s_waitcnt vmcnt(0)
    v_cmp_ne_u32_e64 vcc, s80, v236
    s_cmp_eq_u64 vcc, 0
    s_cbranch_scc1 L_pdone_3
    s_mov_b64 exec, vcc
    s_sleep 2
    s_add_u32 s85, s85, 1
    s_cmp_lt_u32 s85, 0x8000
    s_cbranch_scc1 L_poll_2
L_pdone_3:
    s_mov_b64 exec, -1
L_ok_1:
    s_barrier
    s_nop 0
    v_mfma_f32_32x32x16_bf16 v[32:47], v[112:115], v[120:123], v[32:47]
    ds_read_b64_tr_b16 v[96:97], v18 offset:0
    ds_read_b64_tr_b16 v[98:99], v18 offset:2048
    ds_read_b128 v[104:107], v14 offset:0
    v_and_or_b32 v11, v0, 7, v11
    v_bfe_u32 v13, v0, 3, 2
    v_mfma_f32_32x32x16_bf16 v[48:63], v[112:115], v[124:127], v[48:63]
    ds_read_b128 v[108:111], v14 offset:4096
    ds_read_b64_tr_b16 v[100:101], v19 offset:0
    ds_read_b64_tr_b16 v[102:103], v19 offset:2048
    s_add_u32 m0, s65, 159744
    s_nop 0
    s_nop 0
    buffer_load_dwordx4 v9, s[52:55], s64 offen sc1 lds
    v_mfma_f32_32x32x16_bf16 v[64:79], v[116:119], v[120:123], v[64:79]
    s_add_u32 m0, s81, 81920
    s_add_u32 s84, s69, 695296
    buffer_load_dwordx4 v8, s[48:51], s84 offen lds
    s_lshr_b32 s92, s81, 1
    s_nop 0
    v_lshl_add_u32 v12, v13, 4, v11
    v_mfma_f32_32x32x16_bf16 v[80:95], v[116:119], v[124:127], v[80:95]
    buffer_load_dwordx4 v30, s[48:51], s84 offen offset:1024 lds
    s_and_b32 s93, s92, 1024
    v_lshl_add_u32 v12, v12, 4, s92
    s_and_b32 s92, s3, 6
    s_waitcnt lgkmcnt(0)
    v_mfma_f32_32x32x16_bf16 v[32:47], v[96:99], v[104:107], v[32:47]
    ds_read_b64_tr_b16 v[112:113], v18 offset:8192
    ds_read_b64_tr_b16 v[114:115], v18 offset:10240
    ds_read_b128 v[120:123], v15 offset:0
    v_lshl_add_u32 v11, v11, 2, v13
    s_lshl_b32 s92, s92, 1
    s_nop 0
    s_lshr_b32 s92, 0x4103, s92
    v_mfma_f32_32x32x16_bf16 v[48:63], v[96:99], v[108:111], v[48:63]
    ds_read_b128 v[124:127], v15 offset:4096
    ds_read_b64_tr_b16 v[116:117], v19 offset:8192
    ds_read_b64_tr_b16 v[118:119], v19 offset:10240
    s_add_u32 m0, s81, 32768
    s_add_u32 s84, s69, 465920
    buffer_load_dwordx4 v8, s[48:51], s84 offen lds
    v_mfma_f32_32x32x16_bf16 v[64:79], v[100:103], v[104:107], v[64:79]
    buffer_load_dwordx4 v30, s[48:51], s84 offen offset:1024 lds
    s_and_b32 s92, s92, 15
    s_lshl_b32 s92, s92, 14
    s_add_u32 s92, s92, s93
    v_lshl_add_u32 v11, v11, 4, s92
    v_mfma_f32_32x32x16_bf16 v[80:95], v[100:103], v[108:111], v[80:95]
    s_waitcnt vmcnt(9) lgkmcnt(0)
    s_barrier
    s_nop 0
    v_mfma_f32_32x32x16_bf16 v[32:47], v[112:115], v[120:123], v[32:47]
    ds_read_b64_tr_b16 v[96:97], v18 offset:16384
    ds_read_b64_tr_b16 v[98:99], v18 offset:18432
    ds_read_b128 v[104:107], v16 offset:0
    v_mfma_f32_32x32x16_bf16 v[48:63], v[112:115], v[124:127], v[48:63]
    ds_read_b128 v[108:111], v16 offset:4096
    ds_read_b64_tr_b16 v[100:101], v19 offset:16384
    ds_read_b64_tr_b16 v[102:103], v19 offset:18432
    v_mfma_f32_32x32x16_bf16 v[64:79], v[116:119], v[120:123], v[64:79]
    s_add_u32 m0, s81, 49152
    s_add_u32 s84, s69, 924672
    buffer_load_dwordx4 v8, s[48:51], s84 offen lds
    v_mfma_f32_32x32x16_bf16 v[80:95], v[116:119], v[124:127], v[80:95]
    buffer_load_dwordx4 v30, s[48:51], s84 offen offset:1024 lds
    s_waitcnt lgkmcnt(0)
    s_nop 0
    v_mfma_f32_32x32x16_bf16 v[32:47], v[96:99], v[104:107], v[32:47]
    ds_read_b64_tr_b16 v[112:113], v18 offset:24576
    ds_read_b64_tr_b16 v[114:115], v18 offset:26624
    ds_read_b128 v[120:123], v17 offset:0
    s_add_u32 m0, s81, 0
    s_nop 0
    s_add_u32 s84, s69, 1146880
    buffer_load_dwordx4 v8, s[48:51], s84 offen lds
    v_mfma_f32_32x32x16_bf16 v[48:63], v[96:99], v[108:111], v[48:63]
    ds_read_b128 v[124:127], v17 offset:4096
    ds_read_b64_tr_b16 v[116:117], v19 offset:24576
    ds_read_b64_tr_b16 v[118:119], v19 offset:26624
    buffer_load_dwordx4 v30, s[48:51], s84 offen offset:1024 lds
    v_mfma_f32_32x32x16_bf16 v[64:79], v[100:103], v[104:107], v[64:79]
    s_waitcnt vmcnt(11)
    s_nop 0
    ds_read_b64_tr_b16 v[208:209], v26 offset:57472
    ds_read_b64_tr_b16 v[212:213], v27 offset:57472
    ds_read_b64_tr_b16 v[216:217], v28 offset:57472
    ds_read_b64_tr_b16 v[220:221], v29 offset:57472
    v_mfma_f32_32x32x16_bf16 v[80:95], v[100:103], v[108:111], v[80:95]
    s_waitcnt vmcnt(8) lgkmcnt(0)
    s_barrier
    v_mfma_f32_32x32x16_bf16 v[32:47], v[112:115], v[120:123], v[32:47]
    ds_read_u16 v129, v248
    ds_read_u16 v133, v248 offset:256
    ds_read_u16_d16_hi v130, v248 offset:16
    v_mfma_f32_32x32x16_bf16 v[48:63], v[112:115], v[124:127], v[48:63]
    ds_read_u16_d16_hi v134, v248 offset:272
    ds_read_b64 v[136:137], v249
    v_mfma_f32_32x32x16_bf16 v[64:79], v[116:119], v[120:123], v[64:79]
    ds_read_b64 v[140:141], v249 offset:128
    buffer_load_dwordx4 v[2:5], v21, s[52:55], s66 offen sc1
    s_waitcnt lgkmcnt(0)
    s_nop 0
    v_lshl_or_b32 v128, v129, 16, v129
    v_lshl_or_b32 v132, v133, 16, v133
    v_mfma_f32_32x32x16_bf16 v[80:95], v[116:119], v[124:127], v[80:95]
    v_rcp_f32_e64 v108, v130
    v_mfma_f32_32x32x16_bf16 v[32:47], v[136:139], v[128:131], v[32:47]
    v_rcp_f32_e64 v110, v134
    v_mul_f32 v108, 0xbfb8aa3b, v108
    v_mul_f32 v110, 0xbfb8aa3b, v110
    s_waitcnt vmcnt(5)
    s_nop 0
    v_mfma_f32_32x32x16_bf16 v[48:63], v[136:139], v[132:135], v[48:63]
    ds_read_b64_tr_b16 v[178:179], v22 offset:32768
    ds_read_b64_tr_b16 v[182:183], v23 offset:32768
    ds_read_b64_tr_b16 v[186:187], v24 offset:32768
    v_mfma_f32_32x32x16_bf16 v[64:79], v[140:143], v[128:131], v[64:79]
    ds_read_b64_tr_b16 v[190:191], v25 offset:32768
    ds_read_b64_tr_b16 v[192:193], v26 offset:32768
    v_mfma_f32_32x32x16_bf16 v[80:95], v[140:143], v[132:135], v[80:95]
    ds_read_b64_tr_b16 v[196:197], v27 offset:32768
    ds_read_b64_tr_b16 v[200:201], v28 offset:32768
    ds_read_b64_tr_b16 v[204:205], v29 offset:32768
    s_setprio 3
    s_nop 0
    v_pk_mul_f32 v[32:33], v[32:33], v[108:109] op_sel_hi:[1,0]
    v_pk_mul_f32 v[34:35], v[34:35], v[108:109] op_sel_hi:[1,0]
    v_pk_mul_f32 v[36:37], v[36:37], v[108:109] op_sel_hi:[1,0]
    v_pk_mul_f32 v[38:39], v[38:39], v[108:109] op_sel_hi:[1,0]
    v_exp_f32_e64 v32, v32
    v_exp_f32_e64 v33, v33
    ds_read_b64_tr_b16 v[194:195], v26 offset:16384
    v_exp_f32_e64 v34, v34
    ds_read_b64_tr_b16 v[198:199], v27 offset:16384
    v_exp_f32_e64 v35, v35
    ds_read_b64_tr_b16 v[202:203], v28 offset:16384
    v_exp_f32_e64 v36, v36
    ds_read_b64_tr_b16 v[206:207], v29 offset:16384
    v_exp_f32_e64 v37, v37
    v_exp_f32_e64 v38, v38
    v_exp_f32_e64 v39, v39
    v_pk_fma_f32 v[32:33], v[32:33], v[130:131], v[130:131] op_sel_hi:[1,0,0]
    v_pk_fma_f32 v[34:35], v[34:35], v[130:131], v[130:131] op_sel_hi:[1,0,0]
    v_pk_fma_f32 v[36:37], v[36:37], v[130:131], v[130:131] op_sel_hi:[1,0,0]
    v_pk_fma_f32 v[38:39], v[38:39], v[130:131], v[130:131] op_sel_hi:[1,0,0]
    v_rcp_f32_e64 v32, v32
    v_rcp_f32_e64 v33, v33
    v_rcp_f32_e64 v34, v34
    v_rcp_f32_e64 v35, v35
    s_waitcnt vmcnt(3)
    s_nop 0
    v_rcp_f32_e64 v36, v36
    ds_read_b64_tr_b16 v[210:211], v22 offset:49152
    v_rcp_f32_e64 v37, v37
    ds_read_b64_tr_b16 v[214:215], v23 offset:49152
    v_rcp_f32_e64 v38, v38
    ds_read_b64_tr_b16 v[218:219], v24 offset:49152
    v_rcp_f32_e64 v39, v39
    ds_read_b64_tr_b16 v[222:223], v25 offset:49152
    v_pk_mul_f32 v[40:41], v[40:41], v[32:33]
    v_pk_mul_f32 v[42:43], v[42:43], v[34:35]
    v_pk_mul_f32 v[44:45], v[44:45], v[36:37]
    v_pk_mul_f32 v[46:47], v[46:47], v[38:39]
    v_cvt_pk_bf16_f32 v32, v40, v41
    v_cvt_pk_bf16_f32 v33, v42, v43
    v_cvt_pk_bf16_f32 v34, v44, v45
    v_cvt_pk_bf16_f32 v35, v46, v47
    buffer_store_dwordx4 v[32:35], v250, s[52:55], s67 offen offset:0 sc1
    s_setprio 2
    s_nop 0
    v_pk_mul_f32 v[48:49], v[48:49], v[110:111] op_sel_hi:[1,0]
    v_pk_mul_f32 v[50:51], v[50:51], v[110:111] op_sel_hi:[1,0]
    v_pk_mul_f32 v[52:53], v[52:53], v[110:111] op_sel_hi:[1,0]
    v_pk_mul_f32 v[54:55], v[54:55], v[110:111] op_sel_hi:[1,0]
    v_exp_f32_e64 v48, v48
    s_waitcnt vmcnt(2)
    s_nop 0
    v_exp_f32_e64 v49, v49
    ds_read_b64_tr_b16 v[224:225], v22 offset:0
    v_exp_f32_e64 v50, v50
    ds_read_b64_tr_b16 v[228:229], v23 offset:0
    v_exp_f32_e64 v51, v51
    ds_read_b64_tr_b16 v[232:233], v24 offset:0
    v_exp_f32_e64 v52, v52
    ds_read_b64_tr_b16 v[236:237], v25 offset:0
    v_exp_f32_e64 v53, v53
    v_exp_f32_e64 v54, v54
    v_exp_f32_e64 v55, v55
    v_pk_fma_f32 v[48:49], v[48:49], v[134:135], v[134:135] op_sel_hi:[1,0,0]
    v_pk_fma_f32 v[50:51], v[50:51], v[134:135], v[134:135] op_sel_hi:[1,0,0]
    v_pk_fma_f32 v[52:53], v[52:53], v[134:135], v[134:135] op_sel_hi:[1,0,0]
    v_pk_fma_f32 v[54:55], v[54:55], v[134:135], v[134:135] op_sel_hi:[1,0,0]
    v_rcp_f32_e64 v48, v48
    v_rcp_f32_e64 v49, v49
    v_rcp_f32_e64 v50, v50
    v_rcp_f32_e64 v51, v51
    v_rcp_f32_e64 v52, v52
    v_rcp_f32_e64 v53, v53
    v_rcp_f32_e64 v54, v54
    v_rcp_f32_e64 v55, v55
    v_pk_mul_f32 v[56:57], v[56:57], v[48:49]
    v_pk_mul_f32 v[58:59], v[58:59], v[50:51]
    v_pk_mul_f32 v[60:61], v[60:61], v[52:53]
    v_pk_mul_f32 v[62:63], v[62:63], v[54:55]
    v_cvt_pk_bf16_f32 v48, v56, v57
    v_cvt_pk_bf16_f32 v49, v58, v59
    v_cvt_pk_bf16_f32 v50, v60, v61
    v_cvt_pk_bf16_f32 v51, v62, v63
    buffer_store_dwordx4 v[48:51], v250, s[52:55], s22 offen offset:0 sc1
    s_setprio 1
    s_nop 0
    v_pk_mul_f32 v[64:65], v[64:65], v[108:109] op_sel_hi:[1,0]
    v_pk_mul_f32 v[66:67], v[66:67], v[108:109] op_sel_hi:[1,0]
    v_pk_mul_f32 v[68:69], v[68:69], v[108:109] op_sel_hi:[1,0]
    v_pk_mul_f32 v[70:71], v[70:71], v[108:109] op_sel_hi:[1,0]
    v_exp_f32_e64 v64, v64
    s_waitcnt vmcnt(2)
    ds_write_b128 v20, v[2:5]
    v_exp_f32_e64 v65, v65
    s_and_b32 s4, s3, 2
    s_lshl_b32 s4, s4, 11
    v_exp_f32_e64 v66, v66
    s_lshl_b32 s5, s95, 8
    s_add_u32 s4, s4, s5
    s_nop 0
    v_exp_f32_e64 v67, v67
    s_add_u32 m0, s4, 147968
    s_mul_i32 s4, s3, 4160
    v_exp_f32_e64 v68, v68
    ds_write_addtid_b32 v255
    v_exp_f32_e64 v69, v69
    s_add_u32 m0, s4, 114688
    s_bitcmp1_b32 s3, 1
    s_cselect_b32 s4, 9, 8
    v_exp_f32_e64 v70, v70
    s_bfm_b64 exec, s4, 0
    ds_write_addtid_b32 v255
    s_mov_b64 exec, -1
    v_exp_f32_e64 v71, v71
    s_mul_i32 s4, s94, 16640
    s_add_u32 s4, s4, s5
    s_nop 0
    v_pk_fma_f32 v[64:65], v[64:65], v[130:131], v[130:131] op_sel_hi:[1,0,0]
    v_pk_fma_f32 v[66:67], v[66:67], v[130:131], v[130:131] op_sel_hi:[1,0,0]
    v_pk_fma_f32 v[68:69], v[68:69], v[130:131], v[130:131] op_sel_hi:[1,0,0]
    v_pk_fma_f32 v[70:71], v[70:71], v[130:131], v[130:131] op_sel_hi:[1,0,0]
    v_rcp_f32_e64 v64, v64
    s_add_u32 m0, s4, 114720
    s_nop 0
    s_nop 0
    v_rcp_f32_e64 v65, v65
    ds_write_addtid_b32 v240 offset:4160
    v_rcp_f32_e64 v66, v66
    ds_write_addtid_b32 v241 offset:0
    v_rcp_f32_e64 v67, v67
    ds_write_addtid_b32 v240 offset:12484
    v_rcp_f32_e64 v68, v68
    ds_write_addtid_b32 v241 offset:8324
    v_rcp_f32_e64 v69, v69
    ds_write_addtid_b32 v242 offset:5184
    v_rcp_f32_e64 v70, v70
    ds_write_addtid_b32 v243 offset:1024
    v_rcp_f32_e64 v71, v71
    ds_write_addtid_b32 v242 offset:13508
    v_pk_mul_f32 v[72:73], v[72:73], v[64:65]
    v_pk_mul_f32 v[74:75], v[74:75], v[66:67]
    v_pk_mul_f32 v[76:77], v[76:77], v[68:69]
    v_pk_mul_f32 v[78:79], v[78:79], v[70:71]
    v_cvt_pk_bf16_f32 v64, v72, v73
    v_cvt_pk_bf16_f32 v65, v74, v75
    v_cvt_pk_bf16_f32 v66, v76, v77
    v_cvt_pk_bf16_f32 v67, v78, v79
    buffer_store_dwordx4 v[64:67], v250, s[52:55], s67 offen offset:512 sc1
    s_setprio 0
    s_nop 0
    v_pk_mul_f32 v[80:81], v[80:81], v[110:111] op_sel_hi:[1,0]
    v_pk_mul_f32 v[82:83], v[82:83], v[110:111] op_sel_hi:[1,0]
    v_pk_mul_f32 v[84:85], v[84:85], v[110:111] op_sel_hi:[1,0]
    v_pk_mul_f32 v[86:87], v[86:87], v[110:111] op_sel_hi:[1,0]
    v_exp_f32_e64 v80, v80
    ds_write_addtid_b32 v243 offset:9348
    v_exp_f32_e64 v81, v81
    ds_write_addtid_b32 v244 offset:6208
    v_exp_f32_e64 v82, v82
    ds_write_addtid_b32 v245 offset:2048
    v_exp_f32_e64 v83, v83
    ds_write_addtid_b32 v244 offset:14532
    v_exp_f32_e64 v84, v84
    ds_write_addtid_b32 v245 offset:10372
    v_exp_f32_e64 v85, v85
    ds_write_addtid_b32 v246 offset:7232
    v_exp_f32_e64 v86, v86
    ds_write_addtid_b32 v247 offset:3072
    v_exp_f32_e64 v87, v87
    ds_write_addtid_b32 v246 offset:15556
    v_pk_fma_f32 v[80:81], v[80:81], v[134:135], v[134:135] op_sel_hi:[1,0,0]
    v_pk_fma_f32 v[82:83], v[82:83], v[134:135], v[134:135] op_sel_hi:[1,0,0]
    v_pk_fma_f32 v[84:85], v[84:85], v[134:135], v[134:135] op_sel_hi:[1,0,0]
    v_pk_fma_f32 v[86:87], v[86:87], v[134:135], v[134:135] op_sel_hi:[1,0,0]
    v_rcp_f32_e64 v80, v80
    ds_write_addtid_b32 v247 offset:11396
    v_rcp_f32_e64 v81, v81
    v_rcp_f32_e64 v82, v82
    v_rcp_f32_e64 v83, v83
    v_rcp_f32_e64 v84, v84
    v_rcp_f32_e64 v85, v85
    v_rcp_f32_e64 v86, v86
    v_rcp_f32_e64 v87, v87
    v_pk_mul_f32 v[88:89], v[88:89], v[80:81]
    v_pk_mul_f32 v[90:91], v[90:91], v[82:83]
    v_pk_mul_f32 v[92:93], v[92:93], v[84:85]
    v_pk_mul_f32 v[94:95], v[94:95], v[86:87]
    v_cvt_pk_bf16_f32 v80, v88, v89
    v_cvt_pk_bf16_f32 v81, v90, v91
    v_cvt_pk_bf16_f32 v82, v92, v93
    v_cvt_pk_bf16_f32 v83, v94, v95
    buffer_store_dwordx4 v[80:83], v250, s[52:55], s22 offen offset:512 sc1
    s_waitcnt lgkmcnt(0)
    s_barrier
    ds_read_b64_tr_b16 v[32:33], v6 offset:0
    ds_read_b64_tr_b16 v[34:35], v6 offset:4160
    ds_read_b128 v[36:39], v7 offset:64
    ds_read_b64_tr_b16 v[40:41], v6 offset:512
    ds_read_b64_tr_b16 v[42:43], v6 offset:4672
    ds_read_b128 v[44:47], v7 offset:576
    ds_read_b64_tr_b16 v[48:49], v6 offset:1024
    ds_read_b64_tr_b16 v[50:51], v6 offset:5184
    ds_read_b128 v[52:55], v7 offset:1088
    s_waitcnt lgkmcnt(6)
    s_setprio 3
    v_mfma_f32_16x16x32_bf16 v[96:99], v[32:35], v[36:39], 0
    ds_read_b64_tr_b16 v[56:57], v6 offset:1536
    s_waitcnt lgkmcnt(4)
    s_nop 0
    v_mfma_f32_16x16x32_bf16 v[100:103], v[32:35], v[44:47], 0
    ds_read_b64_tr_b16 v[58:59], v6 offset:5696
    ds_read_b128 v[60:63], v7 offset:1600
    v_mfma_f32_16x16x32_bf16 v[100:103], v[40:43], v[36:39], v[100:103]
    s_add_u32 m0, s81, 32768
    s_add_u32 s84, s69, 1154048
    buffer_load_dwordx4 v8, s[48:51], s84 offen lds
    buffer_load_dwordx4 v30, s[48:51], s84 offen offset:1024 lds
    v_mfma_f32_16x16x32_bf16 v[104:107], v[40:43], v[44:47], 0
    ds_read_b64_tr_b16 v[64:65], v6 offset:2048
    s_waitcnt lgkmcnt(4)
    s_nop 0
    v_mfma_f32_16x16x32_bf16 v[104:107], v[32:35], v[52:55], v[104:107]
    ds_read_b64_tr_b16 v[66:67], v6 offset:6208
    ds_read_b128 v[68:71], v7 offset:2112
    v_mfma_f32_16x16x32_bf16 v[104:107], v[48:51], v[36:39], v[104:107]
    ds_read_b64_tr_b16 v[72:73], v6 offset:2560
    ds_read_b64_tr_b16 v[74:75], v6 offset:6720
    v_mfma_f32_16x16x32_bf16 v[108:111], v[40:43], v[52:55], 0
    ds_read_b128 v[76:79], v7 offset:2624
    ds_read_b64_tr_b16 v[80:81], v6 offset:3072
    v_mfma_f32_16x16x32_bf16 v[108:111], v[48:51], v[44:47], v[108:111]
    ds_read_b64_tr_b16 v[82:83], v6 offset:7232
    ds_read_b128 v[84:87], v7 offset:3136
    v_mfma_f32_16x16x32_bf16 v[112:115], v[48:51], v[52:55], 0
    ds_read_b64_tr_b16 v[88:89], v6 offset:3584
    s_waitcnt lgkmcnt(10)
    s_nop 0
    v_mfma_f32_16x16x32_bf16 v[108:111], v[32:35], v[60:63], v[108:111]
    ds_read_b64_tr_b16 v[90:91], v6 offset:7744
    ds_read_b128 v[92:95], v7 offset:3648
    v_mfma_f32_16x16x32_bf16 v[108:111], v[56:59], v[36:39], v[108:111]
    s_add_u32 m0, s81, 98304
    s_add_u32 s84, s69, 1376256
    buffer_load_dwordx4 v8, s[48:51], s84 offen lds
    buffer_load_dwordx4 v30, s[48:51], s84 offen offset:1024 lds
    v_mfma_f32_16x16x32_bf16 v[112:115], v[40:43], v[60:63], v[112:115]
    v_mfma_f32_16x16x32_bf16 v[116:119], v[48:51], v[60:63], 0
    v_mfma_f32_16x16x32_bf16 v[112:115], v[56:59], v[44:47], v[112:115]
    v_lshrrev_b32 v14, 4, v9
    v_lshrrev_b32 v13, 5, v14
    v_mfma_f32_16x16x32_bf16 v[116:119], v[56:59], v[52:55], v[116:119]
    v_lshlrev_b32_e64 v13, 23, v13
    v_add_lshl_u32 v13, v13, v14, 2
    v_mfma_f32_16x16x32_bf16 v[120:123], v[56:59], v[60:63], 0
    s_add_u32 m0, s81, 81920
    s_add_u32 s84, s69, 1383424
    buffer_load_dwordx4 v8, s[48:51], s84 offen lds
    s_waitcnt lgkmcnt(9)
    v_mfma_f32_16x16x32_bf16 v[112:115], v[32:35], v[68:71], v[112:115]
    buffer_load_dwordx4 v30, s[48:51], s84 offen offset:1024 lds
    s_waitcnt vmcnt(6)
    buffer_store_dword v254, v13, s[52:55], s68 offen sc1
    v_mfma_f32_16x16x32_bf16 v[112:115], v[64:67], v[36:39], v[112:115]
    v_min_u32 v14, 55, v14
    v_lshlrev_b32_e64 v14, 7, v14
    s_setprio 2
    v_mfma_f32_16x16x32_bf16 v[116:119], v[40:43], v[68:71], v[116:119]
    v_mov_b32 v21, 163832
    v_lshrrev_b32_e64 v15, 4, v0
    v_mfma_f32_16x16x32_bf16 v[120:123], v[48:51], v[68:71], v[120:123]
    v_mul_u32_u24 v15, 768, v15
    v_lshl_add_u32 v15, v0, 3, v15
    v_mfma_f32_16x16x32_bf16 v[124:127], v[56:59], v[68:71], 0
    v_mfma_f32_16x16x32_bf16 v[116:119], v[64:67], v[44:47], v[116:119]
    v_mfma_f32_16x16x32_bf16 v[120:123], v[64:67], v[52:55], v[120:123]
    v_mfma_f32_16x16x32_bf16 v[124:127], v[64:67], v[60:63], v[124:127]
    ds_read_b64_tr_b16 v[64:65], v6 offset:64
    s_waitcnt lgkmcnt(7)
    s_nop 0
    v_mfma_f32_16x16x32_bf16 v[116:119], v[32:35], v[76:79], v[116:119]
    ds_read_b64_tr_b16 v[66:67], v6 offset:4224
    ds_read_b128 v[68:71], v7 offset:0
    v_mfma_f32_16x16x32_bf16 v[116:119], v[72:75], v[36:39], v[116:119]
    ds_read_b64_tr_b16 v[56:57], v6 offset:576
    ds_read_b64_tr_b16 v[58:59], v6 offset:4736
    v_mfma_f32_16x16x32_bf16 v[120:123], v[40:43], v[76:79], v[120:123]
    ds_read_b128 v[60:63], v7 offset:512
    v_mfma_f32_16x16x32_bf16 v[124:127], v[48:51], v[76:79], v[124:127]
    v_mfma_f32_16x16x32_bf16 v[120:123], v[72:75], v[44:47], v[120:123]
    v_mfma_f32_16x16x32_bf16 v[124:127], v[72:75], v[52:55], v[124:127]
    ds_read_b64_tr_b16 v[72:73], v6 offset:1088
    s_waitcnt lgkmcnt(10)
    s_nop 0
    v_mfma_f32_16x16x32_bf16 v[120:123], v[32:35], v[84:87], v[120:123]
    ds_read_b64_tr_b16 v[74:75], v6 offset:5248
    ds_read_b128 v[76:79], v7 offset:1024
    v_mfma_f32_16x16x32_bf16 v[120:123], v[80:83], v[36:39], v[120:123]
    ds_read_b64_tr_b16 v[48:49], v6 offset:1600
    ds_read_b64_tr_b16 v[50:51], v6 offset:5760
    v_mfma_f32_16x16x32_bf16 v[124:127], v[40:43], v[84:87], v[124:127]
    ds_read_b128 v[52:55], v7 offset:1536
    v_mfma_f32_16x16x32_bf16 v[124:127], v[80:83], v[44:47], v[124:127]
    ds_read_b64_tr_b16 v[80:81], v6 offset:2112
    s_waitcnt lgkmcnt(13)
    s_nop 0
    v_mfma_f32_16x16x32_bf16 v[124:127], v[32:35], v[92:95], v[124:127]
    ds_read_b64_tr_b16 v[82:83], v6 offset:6272
    ds_read_b128 v[84:87], v7 offset:2048
    v_mfma_f32_16x16x32_bf16 v[124:127], v[88:91], v[36:39], v[124:127]
    ds_read_b64_tr_b16 v[40:41], v6 offset:2624
    s_waitcnt lgkmcnt(13)
    s_setprio 1
    v_mfma_f32_16x16x32_bf16 v[96:99], v[64:67], v[68:71], v[96:99]
    ds_read_b64_tr_b16 v[42:43], v6 offset:6784
    s_waitcnt lgkmcnt(11)
    s_nop 0
    v_mfma_f32_16x16x32_bf16 v[100:103], v[64:67], v[60:63], v[100:103]
    ds_read_b128 v[44:47], v7 offset:2560
    ds_read_b64_tr_b16 v[88:89], v6 offset:3136
    v_mfma_f32_16x16x32_bf16 v[100:103], v[56:59], v[68:71], v[100:103]
    ds_read_b64_tr_b16 v[90:91], v6 offset:7296
    ds_read_b128 v[92:95], v7 offset:3072
    v_mfma_f32_16x16x32_bf16 v[104:107], v[56:59], v[60:63], v[104:107]
    ds_read_b64_tr_b16 v[32:33], v6 offset:3648
    s_waitcnt lgkmcnt(13)
    s_nop 0
    v_mfma_f32_16x16x32_bf16 v[104:107], v[64:67], v[76:79], v[104:107]
    ds_read_b64_tr_b16 v[34:35], v6 offset:7808
    ds_read_b128 v[36:39], v7 offset:3584
    v_mfma_f32_16x16x32_bf16 v[104:107], v[72:75], v[68:71], v[104:107]
    buffer_load_dwordx2 v[2:3], v15, s[36:39], s72 offen
    buffer_load_dwordx2 v[4:5], v15, s[36:39], s74 offen
    v_mfma_f32_16x16x32_bf16 v[108:111], v[56:59], v[76:79], v[108:111]
    v_mfma_f32_16x16x32_bf16 v[108:111], v[72:75], v[60:63], v[108:111]
    v_mfma_f32_16x16x32_bf16 v[112:115], v[72:75], v[76:79], v[112:115]
    s_waitcnt lgkmcnt(12)
    s_nop 0
    v_mfma_f32_16x16x32_bf16 v[108:111], v[64:67], v[52:55], v[108:111]
    v_mfma_f32_16x16x32_bf16 v[108:111], v[48:51], v[68:71], v[108:111]
    v_mfma_f32_16x16x32_bf16 v[112:115], v[56:59], v[52:55], v[112:115]
    v_mfma_f32_16x16x32_bf16 v[116:119], v[72:75], v[52:55], v[116:119]
    v_mfma_f32_16x16x32_bf16 v[112:115], v[48:51], v[60:63], v[112:115]
    v_mfma_f32_16x16x32_bf16 v[116:119], v[48:51], v[76:79], v[116:119]
    s_add_u32 m0, s81, 49152
    s_nop 0
    s_nop 0
    ds_write_addtid_b32 v96 offset:0
    v_mfma_f32_16x16x32_bf16 v[120:123], v[48:51], v[52:55], v[120:123]
    ds_write_addtid_b32 v97 offset:256
    s_waitcnt lgkmcnt(11)
    s_nop 0
    v_mfma_f32_16x16x32_bf16 v[112:115], v[64:67], v[84:87], v[112:115]
    ds_write_addtid_b32 v98 offset:512
    ds_write_addtid_b32 v99 offset:768
    v_mfma_f32_16x16x32_bf16 v[112:115], v[80:83], v[68:71], v[112:115]
    ds_write_addtid_b32 v100 offset:1024
    ds_write_addtid_b32 v101 offset:1280
    s_setprio 0
    s_nop 0
    v_mfma_f32_16x16x32_bf16 v[116:119], v[56:59], v[84:87], v[116:119]
    ds_write_addtid_b32 v102 offset:1536
    ds_write_addtid_b32 v103 offset:1792
    v_mfma_f32_16x16x32_bf16 v[120:123], v[72:75], v[84:87], v[120:123]
    s_add_u32 m0, s81, 0
    s_nop 0
    ds_write_addtid_b32 v104 offset:0
    v_mfma_f32_16x16x32_bf16 v[124:127], v[48:51], v[84:87], v[124:127]
    ds_write_addtid_b32 v105 offset:256
    ds_write_addtid_b32 v106 offset:512
    v_mfma_f32_16x16x32_bf16 v[116:119], v[80:83], v[60:63], v[116:119]
    ds_write_addtid_b32 v107 offset:768
    buffer_load_dword v128, v14, s[52:55], s71 offen sc1
    v_mfma_f32_16x16x32_bf16 v[120:123], v[80:83], v[76:79], v[120:123]
    ds_write_addtid_b32 v108 offset:1024
    ds_write_addtid_b32 v109 offset:1280
    v_mfma_f32_16x16x32_bf16 v[124:127], v[80:83], v[52:55], v[124:127]
    ds_write_addtid_b32 v110 offset:1536
    s_waitcnt lgkmcnt(15)
    s_nop 0
    v_mfma_f32_16x16x32_bf16 v[116:119], v[64:67], v[44:47], v[116:119]
    ds_write_addtid_b32 v111 offset:1792
    v_mfma_f32_16x16x32_bf16 v[116:119], v[40:43], v[68:71], v[116:119]
    s_add_u32 m0, s81, 16384
    s_nop 0
    s_nop 0
    ds_write_addtid_b32 v112 offset:0
    v_mfma_f32_16x16x32_bf16 v[120:123], v[56:59], v[44:47], v[120:123]
    ds_write_addtid_b32 v113 offset:256
    ds_write_addtid_b32 v114 offset:512
    v_mfma_f32_16x16x32_bf16 v[124:127], v[72:75], v[44:47], v[124:127]
    ds_write_addtid_b32 v115 offset:768
    v_mfma_f32_16x16x32_bf16 v[120:123], v[40:43], v[60:63], v[120:123]
    v_mfma_f32_16x16x32_bf16 v[124:127], v[40:43], v[76:79], v[124:127]
    s_waitcnt lgkmcnt(15)
    s_nop 0
    v_mfma_f32_16x16x32_bf16 v[120:123], v[64:67], v[92:95], v[120:123]
    v_mfma_f32_16x16x32_bf16 v[120:123], v[88:91], v[68:71], v[120:123]
    v_mfma_f32_16x16x32_bf16 v[124:127], v[56:59], v[92:95], v[124:127]
    v_mfma_f32_16x16x32_bf16 v[124:127], v[88:91], v[60:63], v[124:127]
    ds_write_addtid_b32 v116 offset:1024
    s_waitcnt lgkmcnt(15)
    s_nop 0
    v_mfma_f32_16x16x32_bf16 v[124:127], v[64:67], v[36:39], v[124:127]
    ds_write_addtid_b32 v117 offset:1280
    ds_write_addtid_b32 v118 offset:1536
    v_mfma_f32_16x16x32_bf16 v[124:127], v[32:35], v[68:71], v[124:127]
    ds_write_addtid_b32 v119 offset:1792
    s_waitcnt vmcnt(0)
    s_cmp_lg_u32 s3, 0
    s_cbranch_scc1 L_hw_4
    v_cmp_ne_u32 vcc, s80, v128
    s_cmp_eq_u64 vcc, 0
    s_cbranch_scc1 L_ok_7
    s_mov_b64 exec, vcc
    s_mov_b32 s85, 0
L_poll_8:
    buffer_load_dword v128, v14, s[52:55], s71 offen offset:0 sc1
    s_waitcnt vmcnt(0)
    v_cmp_ne_u32 vcc, s80, v128
    s_cmp_eq_u64 vcc, 0
    s_cbranch_scc1 L_pdone_9
    s_mov_b64 exec, vcc
    s_add_u32 s85, s85, 1
    s_cmp_lt_u32 s85, 0x8000
    s_cbranch_scc1 L_poll_8
L_pdone_9:
    s_mov_b64 exec, -1
L_ok_7:
    ds_write_b32 v21, v21
    s_branch L_hd_6
L_hw_4:
    s_mov_b32 s85, 0
L_hs_5:
    ds_read_b32 v128, v21
    s_add_u32 s85, s85, 1
    s_waitcnt lgkmcnt(0)
    v_readfirstlane_b32 s4, v128
    s_cmp_lg_u32 s4, 0
    s_cbranch_scc1 L_hd_6
    s_cmp_lt_u32 s85, 0x200000
    s_cbranch_scc1 L_hs_5
L_hd_6:
    s_add_u32 s84, s70, 0
    s_nop 0
    buffer_load_dwordx4 v[64:67], v9, s[52:55], s84 offen sc1
    s_add_u32 s84, s70, 65536
    buffer_load_dwordx4 v[68:71], v9, s[52:55], s84 offen sc1
    s_nop 1
    s_add_u32 m0, s81, 65536
    s_nop 0
    ds_write_addtid_b32 v120 offset:0
    ds_write_addtid_b32 v121 offset:256
    ds_write_addtid_b32 v122 offset:512
    ds_write_addtid_b32 v123 offset:768
    s_add_u32 s84, s70, 131072
    buffer_load_dwordx4 v[72:75], v9, s[52:55], s84 offen sc1
    ds_write_addtid_b32 v124 offset:1024
    ds_write_addtid_b32 v125 offset:1280
    ds_write_addtid_b32 v126 offset:1536
    ds_write_addtid_b32 v127 offset:1792
    ds_read_b64_tr_b16 v[226:227], v22 offset:32768
    s_add_u32 s84, s70, 196608
    buffer_load_dwordx4 v[76:79], v9, s[52:55], s84 offen sc1
    ds_read_b64_tr_b16 v[230:231], v23 offset:32768
    ds_read_b64_tr_b16 v[234:235], v24 offset:32768
    ds_read_b64_tr_b16 v[238:239], v25 offset:32768
    ds_read_b64_tr_b16 v[240:241], v26 offset:32768
    ds_read_b64_tr_b16 v[244:245], v27 offset:32768
    s_add_u32 s84, s70, 262144
    buffer_load_dwordx4 v[80:83], v9, s[52:55], s84 offen sc1
    ds_read_b64_tr_b16 v[248:249], v28 offset:32768
    ds_read_b64_tr_b16 v[252:253], v29 offset:32768
    ds_read_b64_tr_b16 v[242:243], v26 offset:16384
    ds_read_b64_tr_b16 v[246:247], v27 offset:16384
    ds_read_b64_tr_b16 v[250:251], v28 offset:16384
    ds_read_b64_tr_b16 v[254:255], v29 offset:16384
    s_add_u32 s84, s70, 327680
    buffer_load_dwordx4 v[84:87], v9, s[52:55], s84 offen sc1
    s_add_u32 s84, s70, 393216
    buffer_load_dwordx4 v[88:91], v9, s[52:55], s84 offen sc1
    s_add_u32 s84, s70, 4096
    buffer_load_dwordx4 v[92:95], v9, s[52:55], s84 offen sc1
    s_waitcnt lgkmcnt(0)
    s_barrier
    s_setprio 3
    s_waitcnt vmcnt(7)
    v_mfma_f32_16x16x32_bf16 v[32:35], v[64:67], v[144:147], 0
    s_add_u32 s84, s70, 69632
    buffer_load_dwordx4 v[96:99], v9, s[52:55], s84 offen sc1
    v_mfma_f32_16x16x32_bf16 v[36:39], v[64:67], v[148:151], 0
    ds_read_b128 v[128:131], v11 offset:0
    v_mfma_f32_16x16x32_bf16 v[40:43], v[64:67], v[152:155], 0
    ds_read_b128 v[132:135], v11 offset:2048
    ds_read_b128 v[136:139], v11 offset:4096
    v_mfma_f32_16x16x32_bf16 v[44:47], v[64:67], v[156:159], 0
    ds_read_b128 v[140:143], v11 offset:6144
    s_waitcnt vmcnt(7)
    s_nop 0
    v_mfma_f32_16x16x32_bf16 v[32:35], v[68:71], v[160:163], v[32:35]
    s_add_u32 s84, s70, 135168
    buffer_load_dwordx4 v[100:103], v9, s[52:55], s84 offen sc1
    v_mfma_f32_16x16x32_bf16 v[36:39], v[68:71], v[164:167], v[36:39]
    s_waitcnt lgkmcnt(0)
    v_add_f32 v128, v128, v132
    v_mfma_f32_16x16x32_bf16 v[40:43], v[68:71], v[168:171], v[40:43]
    v_add_f32 v136, v136, v140
    v_add_f32 v129, v129, v133
    v_mfma_f32_16x16x32_bf16 v[44:47], v[68:71], v[172:175], v[44:47]
    v_add_f32 v137, v137, v141
    v_add_f32 v130, v130, v134
    s_setprio 2
    s_waitcnt vmcnt(7)
    v_mfma_f32_16x16x32_bf16 v[32:35], v[72:75], v[176:179], v[32:35]
    s_add_u32 s84, s70, 200704
    buffer_load_dwordx4 v[104:107], v9, s[52:55], s84 offen sc1
    v_add_f32_e64 v138, v138, v142
    v_mfma_f32_16x16x32_bf16 v[36:39], v[72:75], v[180:183], v[36:39]
    v_add_f32 v131, v131, v135
    v_add_f32 v139, v139, v143
    v_mfma_f32_16x16x32_bf16 v[40:43], v[72:75], v[184:187], v[40:43]
    v_add_f32 v22, v128, v136
    v_add_f32 v23, v129, v137
    v_mfma_f32_16x16x32_bf16 v[44:47], v[72:75], v[188:191], v[44:47]
    v_add_f32 v24, v130, v138
    v_add_f32_e64 v25, v131, v139
    s_waitcnt vmcnt(7)
    v_mfma_f32_16x16x32_bf16 v[32:35], v[76:79], v[192:195], v[32:35]
    s_add_u32 s84, s70, 266240
    buffer_load_dwordx4 v[108:111], v9, s[52:55], s84 offen sc1
    v_mfma_f32_16x16x32_bf16 v[36:39], v[76:79], v[196:199], v[36:39]
    ds_read_b128 v[128:131], v11 offset:8192
    v_mfma_f32_16x16x32_bf16 v[40:43], v[76:79], v[200:203], v[40:43]
    ds_read_b128 v[132:135], v11 offset:10240
    ds_read_b128 v[136:139], v11 offset:12288
    v_mfma_f32_16x16x32_bf16 v[44:47], v[76:79], v[204:207], v[44:47]
    ds_read_b128 v[140:143], v11 offset:14336
    s_setprio 1
    s_waitcnt vmcnt(7)
    v_mfma_f32_16x16x32_bf16 v[32:35], v[80:83], v[208:211], v[32:35]
    s_waitcnt lgkmcnt(0)
    v_add_f32 v128, v128, v132
    v_mfma_f32_16x16x32_bf16 v[36:39], v[80:83], v[212:215], v[36:39]
    v_add_f32 v136, v136, v140
    v_add_f32 v129, v129, v133
    v_mfma_f32_16x16x32_bf16 v[40:43], v[80:83], v[216:219], v[40:43]
    v_add_f32 v137, v137, v141
    v_add_f32 v130, v130, v134
    v_mfma_f32_16x16x32_bf16 v[44:47], v[80:83], v[220:223], v[44:47]
    v_add_f32 v138, v138, v142
    s_waitcnt vmcnt(6)
    v_mfma_f32_16x16x32_bf16 v[32:35], v[84:87], v[224:227], v[32:35]
    s_add_u32 s84, s70, 331776
    buffer_load_dwordx4 v[112:115], v9, s[52:55], s84 offen sc1
    v_add_f32_e64 v131, v131, v135
    v_mfma_f32_16x16x32_bf16 v[36:39], v[84:87], v[228:231], v[36:39]
    v_add_f32 v139, v139, v143
    v_add_f32 v128, v128, v136
    v_mfma_f32_16x16x32_bf16 v[40:43], v[84:87], v[232:235], v[40:43]
    v_add_f32 v129, v129, v137
    v_add_f32 v130, v130, v138
    v_add_f32_e64 v131, v131, v139
    v_mfma_f32_16x16x32_bf16 v[44:47], v[84:87], v[236:239], v[44:47]
    v_cvt_pk_bf16_f32 v22, v22, v128
    v_cvt_pk_bf16_f32 v23, v23, v129
    s_setprio 0
    s_waitcnt vmcnt(6)
    v_mfma_f32_16x16x32_bf16 v[32:35], v[88:91], v[240:243], v[32:35]
    s_add_u32 s84, s70, 397312
    buffer_load_dwordx4 v[116:119], v9, s[52:55], s84 offen sc1
    v_cvt_pk_bf16_f32 v24, v24, v130
    v_mfma_f32_16x16x32_bf16 v[36:39], v[88:91], v[244:247], v[36:39]
    v_cvt_pk_bf16_f32 v25, v25, v131
    v_min_u32_e64 v22, -2, v22
    v_mfma_f32_16x16x32_bf16 v[40:43], v[88:91], v[248:251], v[40:43]
    v_min_u32 v23, -2, v23
    v_min_u32 v24, -2, v24
    v_min_u32_e64 v25, -2, v25
    v_mfma_f32_16x16x32_bf16 v[44:47], v[88:91], v[252:255], v[44:47]
    buffer_store_dwordx4 v[22:25], v12, s[52:55], s61 offen sc1
    s_mul_i32 m0, s3, 17408
    s_waitcnt vmcnt(7)
    s_nop 0
    v_mfma_f32_16x16x32_bf16 v[48:51], v[92:95], v[144:147], 0
    s_add_u32 s84, s70, 8192
    v_mfma_f32_16x16x32_bf16 v[52:55], v[92:95], v[148:151], 0
    v_mfma_f32_16x16x32_bf16 v[56:59], v[92:95], v[152:155], 0
    buffer_load_dwordx4 v[120:123], v9, s[52:55], s84 offen sc1
    v_mfma_f32_16x16x32_bf16 v[60:63], v[92:95], v[156:159], 0
    s_barrier
    s_setprio 3
    s_waitcnt vmcnt(7)
    s_nop 0
    v_mfma_f32_16x16x32_bf16 v[48:51], v[96:99], v[160:163], v[48:51]
    s_add_u32 s84, s70, 73728
    buffer_load_dwordx4 v[124:127], v9, s[52:55], s84 offen sc1
    v_mfma_f32_16x16x32_bf16 v[52:55], v[96:99], v[164:167], v[52:55]
    v_lshlrev_b32_e64 v136, 16, v2
    v_mfma_f32_16x16x32_bf16 v[56:59], v[96:99], v[168:171], v[56:59]
    v_and_b32 v137, s6, v2
    v_lshlrev_b32 v138, 16, v3
    v_mfma_f32_16x16x32_bf16 v[60:63], v[96:99], v[172:175], v[60:63]
    v_and_b32 v139, s6, v3
    s_waitcnt vmcnt(7)
    v_mfma_f32_16x16x32_bf16 v[48:51], v[100:103], v[176:179], v[48:51]
    ds_write_addtid_b32 v32 offset:0
    ds_write_addtid_b32 v33 offset:256
    v_mfma_f32_16x16x32_bf16 v[52:55], v[100:103], v[180:183], v[52:55]
    ds_write_addtid_b32 v34 offset:512
    v_lshlrev_b32_e64 v140, 16, v4
    v_mfma_f32_16x16x32_bf16 v[56:59], v[100:103], v[184:187], v[56:59]
    v_and_b32 v141, s6, v4
    v_lshlrev_b32 v142, 16, v5
    v_mfma_f32_16x16x32_bf16 v[60:63], v[100:103], v[188:191], v[60:63]
    v_and_b32_e64 v143, s6, v5
    v_bfe_u32 v26, v0, 2, 2
    s_waitcnt vmcnt(6)
    s_nop 0
    v_mfma_f32_16x16x32_bf16 v[48:51], v[104:107], v[192:195], v[48:51]
    s_add_u32 s84, s70, 139264
    buffer_load_dwordx4 v[96:99], v9, s[52:55], s84 offen sc1
    ds_write_addtid_b32 v35 offset:768
    v_mfma_f32_16x16x32_bf16 v[52:55], v[104:107], v[196:199], v[52:55]
    ds_write_addtid_b32 v36 offset:1088
    ds_write_addtid_b32 v37 offset:1344
    v_mul_u32_u24 v26, 1024, v26
    v_mfma_f32_16x16x32_bf16 v[56:59], v[104:107], v[200:203], v[56:59]
    s_mul_i32 s92, s94, 4096
    s_lshl_b32 s93, s3, 6
    s_add_u32 s92, s92, s93
    v_mfma_f32_16x16x32_bf16 v[60:63], v[104:107], v[204:207], v[60:63]
    v_add3_u32 v16, v26, v9, s92
    v_add_u32 v17, 69632, v16
    s_setprio 2
    s_waitcnt vmcnt(6)
    v_mfma_f32_16x16x32_bf16 v[48:51], v[108:111], v[208:211], v[48:51]
    s_add_u32 s84, s70, 204800
    buffer_load_dwordx4 v[100:103], v9, s[52:55], s84 offen sc1
    ds_write_addtid_b32 v38 offset:1600
    v_mfma_f32_16x16x32_bf16 v[52:55], v[108:111], v[212:215], v[52:55]
    ds_write_addtid_b32 v39 offset:1856
    ds_write_addtid_b32 v40 offset:2176
    v_mfma_f32_16x16x32_bf16 v[56:59], v[108:111], v[216:219], v[56:59]
    v_and_b32 v26, 0x70, v0
    v_lshlrev_b32_e64 v27, 3, v0
    s_mov_b32 s92, 139264
    v_mfma_f32_16x16x32_bf16 v[60:63], v[108:111], v[220:223], v[60:63]
    v_xad_u32 v18, v26, v27, s92
    v_and_b32 v26, 3, v0
    s_waitcnt vmcnt(6)
    v_mfma_f32_16x16x32_bf16 v[48:51], v[112:115], v[224:227], v[48:51]
    s_add_u32 s84, s70, 270336
    buffer_load_dwordx4 v[104:107], v9, s[52:55], s84 offen sc1
    ds_write_addtid_b32 v41 offset:2432
    v_mfma_f32_16x16x32_bf16 v[52:55], v[112:115], v[228:231], v[52:55]
    ds_write_addtid_b32 v42 offset:2688
    ds_write_addtid_b32 v43 offset:2944
    v_mfma_f32_16x16x32_bf16 v[56:59], v[112:115], v[232:235], v[56:59]
    v_bfe_u32 v27, v0, 2, 2
    v_lshl_add_u32 v26, v26, 2, v27
    v_and_b32_e64 v27, 7, v26
    v_mfma_f32_16x16x32_bf16 v[60:63], v[112:115], v[236:239], v[60:63]
    v_xor_b32_e64 v27, s3, v27
    v_lshl_add_u32 v26, v26, 3, v27
    s_waitcnt vmcnt(6)
    s_nop 0
    v_mfma_f32_16x16x32_bf16 v[48:51], v[116:119], v[240:243], v[48:51]
    s_add_u32 s84, s70, 335872
    buffer_load_dwordx4 v[108:111], v9, s[52:55], s84 offen sc1
    ds_write_addtid_b32 v44 offset:3264
    v_mfma_f32_16x16x32_bf16 v[52:55], v[116:119], v[244:247], v[52:55]
    ds_write_addtid_b32 v45 offset:3520
    ds_write_addtid_b32 v46 offset:3776
    ds_write_addtid_b32 v47 offset:4032
    v_mfma_f32_16x16x32_bf16 v[56:59], v[116:119], v[248:251], v[56:59]
    v_bfe_u32 v27, v0, 4, 2
    v_lshl_add_u32 v26, v26, 2, v27
    v_lshl_add_u32 v19, v26, 2, s92
    v_mfma_f32_16x16x32_bf16 v[60:63], v[116:119], v[252:255], v[60:63]
    v_lshrrev_b32_e64 v26, 4, v0
    v_and_b32 v27, 0xf0, v9
    v_lshl_add_u32 v20, v26, 13, v27
    s_setprio 1
    s_waitcnt vmcnt(5)
    v_mfma_f32_16x16x32_bf16 v[64:67], v[120:123], v[144:147], 0
    s_add_u32 s84, s70, 401408
    v_mfma_f32_16x16x32_bf16 v[68:71], v[120:123], v[148:151], 0
    v_mfma_f32_16x16x32_bf16 v[72:75], v[120:123], v[152:155], 0
    buffer_load_dwordx4 v[112:115], v9, s[52:55], s84 offen sc1
    v_mfma_f32_16x16x32_bf16 v[76:79], v[120:123], v[156:159], 0
    s_waitcnt vmcnt(5)
    s_nop 0
    v_mfma_f32_16x16x32_bf16 v[64:67], v[124:127], v[160:163], v[64:67]
    s_add_u32 s84, s70, 12288
    v_mfma_f32_16x16x32_bf16 v[68:71], v[124:127], v[164:167], v[68:71]
    v_mfma_f32_16x16x32_bf16 v[72:75], v[124:127], v[168:171], v[72:75]
    buffer_load_dwordx4 v[116:119], v9, s[52:55], s84 offen sc1
    v_mfma_f32_16x16x32_bf16 v[76:79], v[124:127], v[172:175], v[76:79]
    s_waitcnt vmcnt(5)
    s_nop 0
    v_mfma_f32_16x16x32_bf16 v[64:67], v[96:99], v[176:179], v[64:67]
    s_add_u32 s84, s70, 77824
    buffer_load_dwordx4 v[120:123], v9, s[52:55], s84 offen sc1
    v_mfma_f32_16x16x32_bf16 v[68:71], v[96:99], v[180:183], v[68:71]
    ds_write_addtid_b32 v48 offset:4352
    v_mfma_f32_16x16x32_bf16 v[72:75], v[96:99], v[184:187], v[72:75]
    ds_write_addtid_b32 v49 offset:4608
    ds_write_addtid_b32 v50 offset:4864
    v_mfma_f32_16x16x32_bf16 v[76:79], v[96:99], v[188:191], v[76:79]
    ds_write_addtid_b32 v51 offset:5120
    s_setprio 0
    s_waitcnt vmcnt(5)
    v_mfma_f32_16x16x32_bf16 v[64:67], v[100:103], v[192:195], v[64:67]
    s_add_u32 s84, s70, 143360
    buffer_load_dwordx4 v[124:127], v9, s[52:55], s84 offen sc1
    v_mfma_f32_16x16x32_bf16 v[68:71], v[100:103], v[196:199], v[68:71]
    ds_write_addtid_b32 v52 offset:5440
    v_mfma_f32_16x16x32_bf16 v[72:75], v[100:103], v[200:203], v[72:75]
    ds_write_addtid_b32 v53 offset:5696
    ds_write_addtid_b32 v54 offset:5952
    v_mfma_f32_16x16x32_bf16 v[76:79], v[100:103], v[204:207], v[76:79]
    ds_write_addtid_b32 v55 offset:6208
    s_waitcnt vmcnt(5)
    s_nop 0
    v_mfma_f32_16x16x32_bf16 v[64:67], v[104:107], v[208:211], v[64:67]
    s_add_u32 s84, s70, 208896
    buffer_load_dwordx4 v[96:99], v9, s[52:55], s84 offen sc1
    v_mfma_f32_16x16x32_bf16 v[68:71], v[104:107], v[212:215], v[68:71]
    ds_write_addtid_b32 v56 offset:6528
    v_mfma_f32_16x16x32_bf16 v[72:75], v[104:107], v[216:219], v[72:75]
    ds_write_addtid_b32 v57 offset:6784
    ds_write_addtid_b32 v58 offset:7040
    v_mfma_f32_16x16x32_bf16 v[76:79], v[104:107], v[220:223], v[76:79]
    ds_write_addtid_b32 v59 offset:7296
    s_waitcnt vmcnt(5)
    s_nop 0
    v_mfma_f32_16x16x32_bf16 v[64:67], v[108:111], v[224:227], v[64:67]
    s_add_u32 s84, s70, 274432
    buffer_load_dwordx4 v[100:103], v9, s[52:55], s84 offen sc1
    v_mfma_f32_16x16x32_bf16 v[68:71], v[108:111], v[228:231], v[68:71]
    ds_write_addtid_b32 v60 offset:7616
    v_mfma_f32_16x16x32_bf16 v[72:75], v[108:111], v[232:235], v[72:75]
    ds_write_addtid_b32 v61 offset:7872
    ds_write_addtid_b32 v62 offset:8128
    v_mfma_f32_16x16x32_bf16 v[76:79], v[108:111], v[236:239], v[76:79]
    ds_write_addtid_b32 v63 offset:8384
    s_waitcnt lgkmcnt(0)
    s_barrier
    s_setprio 3
    s_waitcnt vmcnt(5)
    v_mfma_f32_16x16x32_bf16 v[64:67], v[112:115], v[240:243], v[64:67]
    s_add_u32 s84, s70, 339968
    buffer_load_dwordx4 v[104:107], v9, s[52:55], s84 offen sc1
    v_mfma_f32_16x16x32_bf16 v[68:71], v[112:115], v[244:247], v[68:71]
    ds_read_b128 v[32:35], v16 offset:0
    v_mfma_f32_16x16x32_bf16 v[72:75], v[112:115], v[248:251], v[72:75]
    ds_read_b128 v[36:39], v16 offset:17408
    ds_read_b128 v[40:43], v16 offset:34816
    v_mfma_f32_16x16x32_bf16 v[76:79], v[112:115], v[252:255], v[76:79]
    ds_read_b128 v[44:47], v16 offset:52224
    s_waitcnt vmcnt(5)
    s_nop 0
    v_mfma_f32_16x16x32_bf16 v[80:83], v[116:119], v[144:147], 0
    s_add_u32 s84, s70, 405504
    buffer_load_dwordx4 v[108:111], v9, s[52:55], s84 offen sc1
    v_mfma_f32_16x16x32_bf16 v[84:87], v[116:119], v[148:151], 0
    ds_read_b128 v[48:51], v17 offset:0
    v_mfma_f32_16x16x32_bf16 v[88:91], v[116:119], v[152:155], 0
    ds_read_b128 v[52:55], v17 offset:17408
    ds_read_b128 v[56:59], v17 offset:34816
    v_mfma_f32_16x16x32_bf16 v[92:95], v[116:119], v[156:159], 0
    ds_read_b128 v[60:63], v17 offset:52224
    s_setprio 2
    s_waitcnt vmcnt(5)
    v_mfma_f32_16x16x32_bf16 v[80:83], v[120:123], v[160:163], v[80:83]
    buffer_load_dwordx4 v[128:131], v20, s[52:55], s73 offen sc1
    s_waitcnt lgkmcnt(4)
    v_mfma_f32_16x16x32_bf16 v[84:87], v[120:123], v[164:167], v[84:87]
    v_add_f32 v136, v136, v32
    v_mfma_f32_16x16x32_bf16 v[88:91], v[120:123], v[168:171], v[88:91]
    v_add_f32 v137, v137, v33
    v_add_f32 v138, v138, v34
    v_mfma_f32_16x16x32_bf16 v[92:95], v[120:123], v[172:175], v[92:95]
    v_add_f32 v139, v139, v35
    s_waitcnt vmcnt(5)
    v_mfma_f32_16x16x32_bf16 v[80:83], v[124:127], v[176:179], v[80:83]
    ds_write_addtid_b32 v64 offset:8704
    ds_write_addtid_b32 v65 offset:8960
    ds_write_addtid_b32 v66 offset:9216
    v_mfma_f32_16x16x32_bf16 v[84:87], v[124:127], v[180:183], v[84:87]
    v_add_f32 v136, v136, v36
    v_add_f32 v137, v137, v37
    v_mfma_f32_16x16x32_bf16 v[88:91], v[124:127], v[184:187], v[88:91]
    v_add_f32 v138, v138, v38
    v_add_f32 v139, v139, v39
    v_mfma_f32_16x16x32_bf16 v[92:95], v[124:127], v[188:191], v[92:95]
    v_add_f32 v136, v136, v40
    v_add_f32 v137, v137, v41
    s_setprio 1
    s_waitcnt vmcnt(4)
    v_mfma_f32_16x16x32_bf16 v[80:83], v[96:99], v[192:195], v[80:83]
    ds_write_addtid_b32 v67 offset:9472
    ds_write_addtid_b32 v68 offset:9792
    ds_write_addtid_b32 v69 offset:10048
    v_mfma_f32_16x16x32_bf16 v[84:87], v[96:99], v[196:199], v[84:87]
    v_add_f32 v138, v138, v42
    v_add_f32 v139, v139, v43
    v_mfma_f32_16x16x32_bf16 v[88:91], v[96:99], v[200:203], v[88:91]
    v_add_f32 v136, v136, v44
    v_add_f32 v137, v137, v45
    v_mfma_f32_16x16x32_bf16 v[92:95], v[96:99], v[204:207], v[92:95]
    v_add_f32 v138, v138, v46
    v_add_f32_e64 v139, v139, v47
    s_waitcnt vmcnt(3)
    v_mfma_f32_16x16x32_bf16 v[80:83], v[100:103], v[208:211], v[80:83]
    ds_write_addtid_b32 v70 offset:10304
    ds_write_addtid_b32 v71 offset:10560
    v_mfma_f32_16x16x32_bf16 v[84:87], v[100:103], v[212:215], v[84:87]
    ds_write_addtid_b32 v72 offset:10880
    s_waitcnt lgkmcnt(9)
    v_mfma_f32_16x16x32_bf16 v[88:91], v[100:103], v[216:219], v[88:91]
    v_add_f32 v136, v136, v48
    v_add_f32_e64 v137, v137, v49
    v_mfma_f32_16x16x32_bf16 v[92:95], v[100:103], v[220:223], v[92:95]
    v_add_f32 v138, v138, v50
    v_add_f32 v139, v139, v51
    s_setprio 0
    s_waitcnt vmcnt(2)
    v_mfma_f32_16x16x32_bf16 v[80:83], v[104:107], v[224:227], v[80:83]
    ds_write_addtid_b32 v73 offset:11136
    ds_write_addtid_b32 v74 offset:11392
    ds_write_addtid_b32 v75 offset:11648
    v_mfma_f32_16x16x32_bf16 v[84:87], v[104:107], v[228:231], v[84:87]
    v_add_f32 v136, v136, v52
    v_add_f32 v137, v137, v53
    v_mfma_f32_16x16x32_bf16 v[88:91], v[104:107], v[232:235], v[88:91]
    v_add_f32 v138, v138, v54
    v_add_f32 v139, v139, v55
    v_mfma_f32_16x16x32_bf16 v[92:95], v[104:107], v[236:239], v[92:95]
    v_add_f32 v136, v136, v56
    v_add_f32_e64 v137, v137, v57
    s_waitcnt vmcnt(1)
    v_mfma_f32_16x16x32_bf16 v[80:83], v[108:111], v[240:243], v[80:83]
    ds_write_addtid_b32 v76 offset:11968
    ds_write_addtid_b32 v77 offset:12224
    ds_write_addtid_b32 v78 offset:12480
    v_mfma_f32_16x16x32_bf16 v[84:87], v[108:111], v[244:247], v[84:87]
    ds_write_addtid_b32 v79 offset:12736
    v_add_f32_e64 v138, v138, v58
    v_mfma_f32_16x16x32_bf16 v[88:91], v[108:111], v[248:251], v[88:91]
    v_add_f32 v139, v139, v59
    v_add_f32 v136, v136, v60
    v_add_f32_e64 v137, v137, v61
    v_mfma_f32_16x16x32_bf16 v[92:95], v[108:111], v[252:255], v[92:95]
    v_add_f32 v138, v138, v62
    v_add_f32_e64 v139, v139, v63
    s_nop 4
    ds_write_addtid_b32 v80 offset:13056
    ds_write_addtid_b32 v81 offset:13312
    ds_write_addtid_b32 v82 offset:13568
    ds_write_addtid_b32 v83 offset:13824
    ds_write_addtid_b32 v84 offset:14144
    ds_write_addtid_b32 v85 offset:14400
    ds_write_addtid_b32 v86 offset:14656
    ds_write_addtid_b32 v87 offset:14912
    ds_write_addtid_b32 v88 offset:15232
    ds_write_addtid_b32 v89 offset:15488
    ds_write_addtid_b32 v90 offset:15744
    ds_write_addtid_b32 v91 offset:16000
    ds_write_addtid_b32 v92 offset:16320
    ds_write_addtid_b32 v93 offset:16576
    ds_write_addtid_b32 v94 offset:16832
    ds_write_addtid_b32 v95 offset:17088
    s_mov_b32 s85, 0
L_ytry_10:
    s_waitcnt vmcnt(0)
    v_max_u32_e64 v132, v128, v129
    v_max3_u32 v132, v132, v130, v131
    v_cmp_eq_u32 vcc, -1, v132
    s_cmp_eq_u64 vcc, 0
    s_cbranch_scc1 L_yok_11
    s_sleep 4
    buffer_load_dwordx4 v[128:131], v20, s[52:55], s73 offen sc1
    s_add_u32 s85, s85, 1
    s_cmp_lt_u32 s85, 0x8000
    s_cbranch_scc1 L_ytry_10
    s_waitcnt vmcnt(0)
L_yok_11:
    s_nop 0
    ds_write_b32 v19, v128
    ds_write_b32 v19, v129 offset:2048
    ds_write_b32 v19, v130 offset:4096
    ds_write_b32 v19, v131 offset:6144
    s_waitcnt lgkmcnt(0)
    s_barrier
    ds_read_b64 v[4:5], v18
    ds_read_b64 v[6:7], v18 offset:4096
    ds_read_b128 v[32:35], v16 offset:8704
    ds_read_b128 v[36:39], v16 offset:26112
    ds_read_b128 v[40:43], v16 offset:43520
    ds_read_b128 v[44:47], v16 offset:60928
    ds_read_b128 v[48:51], v17 offset:8704
    ds_read_b128 v[52:55], v17 offset:26112
    ds_read_b128 v[56:59], v17 offset:43520
    ds_read_b128 v[60:63], v17 offset:60928
    s_waitcnt lgkmcnt(8)
    v_lshlrev_b32 v96, 16, v4
    v_and_b32 v97, s6, v4
    v_lshlrev_b32 v98, 16, v5
    v_and_b32 v99, s6, v5
    v_lshlrev_b32 v100, 16, v6
    v_and_b32 v101, s6, v6
    v_lshlrev_b32 v102, 16, v7
    v_and_b32_e64 v103, s6, v7
    v_pk_add_f32 v[136:137], v[136:137], v[96:97]
    v_pk_add_f32 v[138:139], v[138:139], v[98:99]
    v_pk_add_f32 v[140:141], v[140:141], v[100:101]
    v_pk_add_f32 v[142:143], v[142:143], v[102:103]
    v_cvt_pk_bf16_f32 v4, v136, v137
    v_cvt_pk_bf16_f32 v5, v138, v139
    buffer_store_dwordx2 v[4:5], v15, s[56:59], s72 offen sc1
    s_waitcnt lgkmcnt(6)
    s_nop 0
    v_pk_add_f32 v[140:141], v[140:141], v[32:33]
    v_pk_add_f32 v[142:143], v[142:143], v[34:35]
    v_pk_add_f32 v[140:141], v[140:141], v[36:37]
    v_pk_add_f32 v[142:143], v[142:143], v[38:39]
    s_waitcnt lgkmcnt(4)
    s_nop 0
    v_pk_add_f32 v[140:141], v[140:141], v[40:41]
    v_pk_add_f32 v[142:143], v[142:143], v[42:43]
    v_pk_add_f32 v[140:141], v[140:141], v[44:45]
    v_pk_add_f32 v[142:143], v[142:143], v[46:47]
    s_waitcnt lgkmcnt(2)
    s_nop 0
    v_pk_add_f32 v[140:141], v[140:141], v[48:49]
    v_pk_add_f32 v[142:143], v[142:143], v[50:51]
    v_pk_add_f32 v[140:141], v[140:141], v[52:53]
    v_pk_add_f32 v[142:143], v[142:143], v[54:55]
    s_waitcnt lgkmcnt(0)
    s_nop 0
    v_pk_add_f32 v[140:141], v[140:141], v[56:57]
    v_pk_add_f32 v[142:143], v[142:143], v[58:59]
    v_pk_add_f32 v[140:141], v[140:141], v[60:61]
    v_pk_add_f32 v[142:143], v[142:143], v[62:63]
    v_cvt_pk_bf16_f32 v6, v140, v141
    v_cvt_pk_bf16_f32 v7, v142, v143
    buffer_store_dwordx2 v[6:7], v15, s[56:59], s74 offen sc1
L_exit:
    s_endpgm
L_helper:
    s_load_dwordx16 s[60:75], s[82:83], s85
    v_lshl_add_u32 v236, v2, 6, v1
    v_and_b32 v116, 48, v1
    v_and_b32 v115, -4, v0
    s_movk_i32 s92, 1088
    v_lshrrev_b32_e64 v111, 1, v116
    v_lshl_add_u32 v238, v115, 12, v116
    v_bfe_u32 v110, v0, 2, 2
    v_lshrrev_b32_e64 v109, 4, v0
    v_lshl_add_u32 v116, v109, 5, v111
    v_mad_u32_u24 v237, v110, s92, v116
    v_add_u32 v236, 135168, v236
    v_add_u32 v237, 135168, v237
    v_lshrrev_b32 v252, 5, v0
    v_lshlrev_b32 v252, 23, v252
    v_add_lshl_u32 v252, v252, v0, 2
    v_mov_b32 v255, 0
    v_lshrrev_b32 v6, 4, v0
    v_mul_u32_u24 v6, 3584, v6
    v_and_b32_e64 v7, 15, v0
    v_lshl_add_u32 v14, v7, 4, v6
    s_waitcnt lgkmcnt(0)
    s_mov_b64 s[36:37], s[4:5]
    buffer_load_dwordx4 v[56:59], v55, s[36:39], s77 offen
    s_load_dword s80, s[34:35], 0
    s_bitcmp1_b32 s75, 0
    s_cselect_b64 s[40:41], s[26:27], s[24:25]
    s_cmp_lt_u32 s75, 14
    s_cselect_b32 s42, 1605632, 0
    s_mov_b32 s43, 0x20000
    s_mov_b64 s[48:49], s[28:29]
    s_mov_b32 s50, 1605632
    s_mov_b32 s51, 0x20000
    s_mov_b64 s[52:53], s[34:35]
    s_mov_b32 s54, 1982464
    s_mov_b32 s55, 0x20000
    s_add_u32 s84, s72, 0
    buffer_load_dwordx4 v[128:131], v14, s[40:43], s84 offen
    s_add_u32 s84, s72, 114688
    buffer_load_dwordx4 v[132:135], v14, s[40:43], s84 offen
    s_add_u32 s84, s72, 229376
    buffer_load_dwordx4 v[136:139], v14, s[40:43], s84 offen
    s_add_u32 s84, s72, 344064
    buffer_load_dwordx4 v[140:143], v14, s[40:43], s84 offen
    s_mov_b32 s4, 0x3f803f80
    s_mov_b32 s6, 0xffff0000
    s_waitcnt vmcnt(4)
    s_nop 0
    v_dot2_f32_bf16 v60, v56, s4, 0
    v_dot2_f32_bf16 v61, v56, v56, 0
    v_dot2_f32_bf16 v60, v57, s4, v60
    v_dot2_f32_bf16 v61, v57, v57, v61
    v_dot2_f32_bf16 v60, v58, s4, v60
    v_dot2_f32_bf16 v61, v58, v58, v61
    v_dot2_f32_bf16 v60, v59, s4, v60
    v_dot2_f32_bf16 v61, v59, v59, v61
    v_lshlrev_b32 v96, 16, v56
    v_and_b32 v97, s6, v56
    v_lshlrev_b32 v98, 16, v57
    v_permlane32_swap_b32 v60, v61
    v_add_f32 v60, v60, v61
    v_and_b32 v99, s6, v57
    v_lshlrev_b32_e64 v100, 16, v58
    v_add_f32_dpp v60, v60, v60 quad_perm:[1,0,3,2] row_mask:0xf bank_mask:0xf
    v_and_b32 v101, s6, v58
    v_lshlrev_b32 v102, 16, v59
    v_add_f32_dpp v60, v60, v60 quad_perm:[2,3,0,1] row_mask:0xf bank_mask:0xf
    v_and_b32_e64 v103, s6, v59
    v_mov_b32 v63, 0x3b124925
    v_add_f32_dpp v60, v60, v60 row_half_mirror row_mask:0xf bank_mask:0xf
    s_nop 1
    v_add_f32_dpp v60, v60, v60 row_mirror row_mask:0xf bank_mask:0xf
    s_nop 1
    v_add_f32_dpp v60, v60, v60 row_bcast:15 row_mask:0xa bank_mask:0xf
    s_nop 0
    v_readlane_b32 s4, v60, 16
    v_readlane_b32 s5, v60, 48
    s_nop 0
    v_mul_f32 v60, s4, v63
    v_mul_f32 v62, s5, v63
    v_fma_f32 v62, -v60, v60, v62
    v_max_f32_e64 v62, 0, v62
    v_cvt_pk_bf16_f32 v56, -v60, v62
    v_and_b32_e64 v62, s6, v56
    v_add_f32 v62, 0x3727c5ac, v62
    v_cvt_pk_bf16_f32 v62, v62, v62
    v_and_b32 v62, s6, v62
    v_sqrt_f32 v62, v62
    v_lshlrev_b32_e64 v60, 16, v56
    v_cvt_pk_bf16_f32 v56, v60, v62
    v_and_b32 v62, s6, v56
    v_rcp_f32 v62, v62
    s_nop 0
    v_mul_f32 v60, v60, v62
    v_pk_fma_f32 v[96:97], v[96:97], v[62:63], v[60:61] op_sel_hi:[1,0,0]
    v_pk_fma_f32 v[98:99], v[98:99], v[62:63], v[60:61] op_sel_hi:[1,0,0]
    v_pk_fma_f32 v[100:101], v[100:101], v[62:63], v[60:61] op_sel_hi:[1,0,0]
    v_pk_fma_f32 v[102:103], v[102:103], v[62:63], v[60:61] op_sel_hi:[1,0,0]
    v_cvt_pk_bf16_f32 v96, v96, v97
    v_cvt_pk_bf16_f32 v97, v98, v99
    v_cvt_pk_bf16_f32 v98, v100, v101
    v_cvt_pk_bf16_f32 v99, v102, v103
    v_cndmask_b32_e64 v96, v96, v56, vcc
    ds_write_b128 v236, v[96:99]
    s_waitcnt lgkmcnt(0)
    s_barrier
    ds_read_b64_tr_b16 v[108:109], v237
    ds_read_b64_tr_b16 v[110:111], v237 offset:4352
    s_waitcnt lgkmcnt(0)
    s_nop 0
    buffer_store_dwordx4 v[108:111], v238, s[52:55], s60 offen sc1
    s_mov_b32 s54, 16777216
    s_mul_i32 s80, s80, 0x41c64e6d
    s_add_u32 s80, s80, 0x3c6ef35f
    v_mov_b32_e64 v254, s80
    s_add_u32 s84, s72, 458752
    buffer_load_dwordx4 v[144:147], v14, s[40:43], s84 offen
    s_add_u32 s84, s72, 573440
    buffer_load_dwordx4 v[148:151], v14, s[40:43], s84 offen
    s_waitcnt vmcnt(6)
    v_lshlrev_b32 v184, 16, v128
    v_and_b32 v185, s6, v128
    v_lshlrev_b32 v186, 16, v129
    v_and_b32 v187, s6, v129
    v_lshlrev_b32 v188, 16, v130
    v_and_b32 v189, s6, v130
    v_lshlrev_b32 v190, 16, v131
    v_and_b32_e64 v191, s6, v131
    s_add_u32 s84, s72, 688128
    buffer_load_dwordx4 v[152:155], v14, s[40:43], s84 offen
    s_waitcnt vmcnt(6)
    v_lshlrev_b32 v32, 16, v132
    v_and_b32 v33, s6, v132
    v_lshlrev_b32 v34, 16, v133
    v_and_b32 v35, s6, v133
    v_lshlrev_b32 v36, 16, v134
    v_and_b32 v37, s6, v134
    v_lshlrev_b32 v38, 16, v135
    v_and_b32_e64 v39, s6, v135
    v_pk_add_f32 v[184:185], v[184:185], v[32:33]
    v_pk_add_f32 v[186:187], v[186:187], v[34:35]
    v_pk_add_f32 v[188:189], v[188:189], v[36:37]
    v_pk_add_f32 v[190:191], v[190:191], v[38:39]
    s_add_u32 s84, s72, 802816
    buffer_load_dwordx4 v[156:159], v14, s[40:43], s84 offen
    s_waitcnt vmcnt(6)
    v_lshlrev_b32 v32, 16, v136
    v_and_b32 v33, s6, v136
    v_lshlrev_b32 v34, 16, v137
    v_and_b32 v35, s6, v137
    v_lshlrev_b32 v36, 16, v138
    v_and_b32 v37, s6, v138
    v_lshlrev_b32 v38, 16, v139
    v_and_b32_e64 v39, s6, v139
    v_pk_add_f32 v[184:185], v[184:185], v[32:33]
    v_pk_add_f32 v[186:187], v[186:187], v[34:35]
    v_pk_add_f32 v[188:189], v[188:189], v[36:37]
    v_pk_add_f32 v[190:191], v[190:191], v[38:39]
    s_add_u32 s84, s72, 917504
    buffer_load_dwordx4 v[160:163], v14, s[40:43], s84 offen
    s_waitcnt vmcnt(6)
    v_lshlrev_b32 v32, 16, v140
    v_and_b32 v33, s6, v140
    v_lshlrev_b32 v34, 16, v141
    v_and_b32 v35, s6, v141
    v_lshlrev_b32 v36, 16, v142
    v_and_b32 v37, s6, v142
    v_lshlrev_b32 v38, 16, v143
    v_and_b32_e64 v39, s6, v143
    v_pk_add_f32 v[184:185], v[184:185], v[32:33]
    v_pk_add_f32 v[186:187], v[186:187], v[34:35]
    v_pk_add_f32 v[188:189], v[188:189], v[36:37]
    v_pk_add_f32 v[190:191], v[190:191], v[38:39]
    s_add_u32 s84, s72, 1032192
    buffer_load_dwordx4 v[164:167], v14, s[40:43], s84 offen
    s_waitcnt vmcnt(5)
    v_lshlrev_b32 v32, 16, v144
    v_and_b32 v33, s6, v144
    v_lshlrev_b32 v34, 16, v145
    v_and_b32 v35, s6, v145
    v_lshlrev_b32 v36, 16, v146
    v_and_b32 v37, s6, v146
    v_lshlrev_b32 v38, 16, v147
    v_and_b32_e64 v39, s6, v147
    v_pk_add_f32 v[184:185], v[184:185], v[32:33]
    v_pk_add_f32 v[186:187], v[186:187], v[34:35]
    v_pk_add_f32 v[188:189], v[188:189], v[36:37]
    v_pk_add_f32 v[190:191], v[190:191], v[38:39]
    s_barrier
    s_nop 0
    buffer_store_dword v254, v252, s[52:55], s62 offen sc1
    s_add_u32 s84, s72, 1146880
    buffer_load_dwordx4 v[168:171], v14, s[40:43], s84 offen
    s_waitcnt vmcnt(6)
    v_lshlrev_b32 v32, 16, v148
    v_and_b32 v33, s6, v148
    v_lshlrev_b32 v34, 16, v149
    v_and_b32 v35, s6, v149
    v_lshlrev_b32 v36, 16, v150
    v_and_b32 v37, s6, v150
    v_lshlrev_b32 v38, 16, v151
    v_and_b32_e64 v39, s6, v151
    v_pk_add_f32 v[184:185], v[184:185], v[32:33]
    v_pk_add_f32 v[186:187], v[186:187], v[34:35]
    v_pk_add_f32 v[188:189], v[188:189], v[36:37]
    v_pk_add_f32 v[190:191], v[190:191], v[38:39]
    s_add_u32 s84, s72, 1261568
    buffer_load_dwordx4 v[172:175], v14, s[40:43], s84 offen
    s_waitcnt vmcnt(6)
    v_lshlrev_b32 v32, 16, v152
    v_and_b32 v33, s6, v152
    v_lshlrev_b32 v34, 16, v153
    v_and_b32 v35, s6, v153
    v_lshlrev_b32 v36, 16, v154
    v_and_b32 v37, s6, v154
    v_lshlrev_b32 v38, 16, v155
    v_and_b32_e64 v39, s6, v155
    v_pk_add_f32 v[184:185], v[184:185], v[32:33]
    v_pk_add_f32 v[186:187], v[186:187], v[34:35]
    v_pk_add_f32 v[188:189], v[188:189], v[36:37]
    v_pk_add_f32 v[190:191], v[190:191], v[38:39]
    s_add_u32 s84, s72, 1376256
    buffer_load_dwordx4 v[176:179], v14, s[40:43], s84 offen
    s_waitcnt vmcnt(6)
    v_lshlrev_b32 v32, 16, v156
    v_and_b32 v33, s6, v156
    v_lshlrev_b32 v34, 16, v157
    v_and_b32 v35, s6, v157
    v_lshlrev_b32 v36, 16, v158
    v_and_b32 v37, s6, v158
    v_lshlrev_b32 v38, 16, v159
    v_and_b32_e64 v39, s6, v159
    v_pk_add_f32 v[184:185], v[184:185], v[32:33]
    v_pk_add_f32 v[186:187], v[186:187], v[34:35]
    v_pk_add_f32 v[188:189], v[188:189], v[36:37]
    v_pk_add_f32 v[190:191], v[190:191], v[38:39]
    s_add_u32 s84, s72, 1490944
    buffer_load_dwordx4 v[180:183], v14, s[40:43], s84 offen
    s_waitcnt vmcnt(6)
    v_lshlrev_b32 v32, 16, v160
    v_and_b32 v33, s6, v160
    v_lshlrev_b32 v34, 16, v161
    v_and_b32 v35, s6, v161
    v_lshlrev_b32 v36, 16, v162
    v_and_b32 v37, s6, v162
    v_lshlrev_b32 v38, 16, v163
    v_and_b32_e64 v39, s6, v163
    v_pk_add_f32 v[184:185], v[184:185], v[32:33]
    v_pk_add_f32 v[186:187], v[186:187], v[34:35]
    v_pk_add_f32 v[188:189], v[188:189], v[36:37]
    v_pk_add_f32 v[190:191], v[190:191], v[38:39]
    s_waitcnt vmcnt(5)
    v_lshlrev_b32 v32, 16, v164
    v_and_b32 v33, s6, v164
    v_lshlrev_b32 v34, 16, v165
    v_and_b32 v35, s6, v165
    v_lshlrev_b32 v36, 16, v166
    v_and_b32 v37, s6, v166
    v_lshlrev_b32 v38, 16, v167
    v_and_b32_e64 v39, s6, v167
    v_pk_add_f32 v[184:185], v[184:185], v[32:33]
    v_pk_add_f32 v[186:187], v[186:187], v[34:35]
    v_pk_add_f32 v[188:189], v[188:189], v[36:37]
    v_pk_add_f32 v[190:191], v[190:191], v[38:39]
    s_waitcnt vmcnt(3)
    v_lshlrev_b32 v32, 16, v168
    v_and_b32 v33, s6, v168
    v_lshlrev_b32 v34, 16, v169
    v_and_b32 v35, s6, v169
    v_lshlrev_b32 v36, 16, v170
    v_and_b32 v37, s6, v170
    v_lshlrev_b32 v38, 16, v171
    v_and_b32_e64 v39, s6, v171
    v_pk_add_f32 v[184:185], v[184:185], v[32:33]
    v_pk_add_f32 v[186:187], v[186:187], v[34:35]
    v_pk_add_f32 v[188:189], v[188:189], v[36:37]
    v_pk_add_f32 v[190:191], v[190:191], v[38:39]
    s_waitcnt vmcnt(2)
    v_lshlrev_b32 v32, 16, v172
    v_and_b32 v33, s6, v172
    v_lshlrev_b32 v34, 16, v173
    v_and_b32 v35, s6, v173
    v_lshlrev_b32 v36, 16, v174
    v_and_b32 v37, s6, v174
    v_lshlrev_b32 v38, 16, v175
    v_and_b32_e64 v39, s6, v175
    v_pk_add_f32 v[184:185], v[184:185], v[32:33]
    v_pk_add_f32 v[186:187], v[186:187], v[34:35]
    v_pk_add_f32 v[188:189], v[188:189], v[36:37]
    v_pk_add_f32 v[190:191], v[190:191], v[38:39]
    s_waitcnt vmcnt(1)
    v_lshlrev_b32 v32, 16, v176
    v_and_b32 v33, s6, v176
    v_lshlrev_b32 v34, 16, v177
    v_and_b32 v35, s6, v177
    v_lshlrev_b32 v36, 16, v178
    v_and_b32 v37, s6, v178
    v_lshlrev_b32 v38, 16, v179
    v_and_b32_e64 v39, s6, v179
    v_pk_add_f32 v[184:185], v[184:185], v[32:33]
    v_pk_add_f32 v[186:187], v[186:187], v[34:35]
    v_pk_add_f32 v[188:189], v[188:189], v[36:37]
    v_pk_add_f32 v[190:191], v[190:191], v[38:39]
    s_waitcnt vmcnt(0)
    v_lshlrev_b32 v32, 16, v180
    v_and_b32 v33, s6, v180
    v_lshlrev_b32 v34, 16, v181
    v_and_b32 v35, s6, v181
    v_lshlrev_b32 v36, 16, v182
    v_and_b32 v37, s6, v182
    v_lshlrev_b32 v38, 16, v183
    v_and_b32_e64 v39, s6, v183
    v_pk_add_f32 v[184:185], v[184:185], v[32:33]
    v_pk_add_f32 v[186:187], v[186:187], v[34:35]
    v_pk_add_f32 v[188:189], v[188:189], v[36:37]
    v_pk_add_f32 v[190:191], v[190:191], v[38:39]
    v_lshlrev_b32_e64 v2, 5, v0
    ds_write_b128 v2, v[184:187]
    ds_write_b128 v2, v[188:191] offset:16
    s_waitcnt lgkmcnt(0)
    s_barrier
    s_cmp_lg_u32 s3, 0
    s_cbranch_scc1 L_h_end
    s_cmp_ge_u32 s75, 14
    s_cbranch_scc1 L_h_nosum
    v_lshlrev_b32_e64 v2, 3, v0
    ds_read2st64_b64 v[128:131], v2 offset0:0 offset1:1
    ds_read2st64_b64 v[132:135], v2 offset0:2 offset1:3
    ds_read2st64_b64 v[136:139], v2 offset0:4 offset1:5
    ds_read2st64_b64 v[140:143], v2 offset0:6 offset1:7
    ds_read2st64_b64 v[144:147], v2 offset0:8 offset1:9
    ds_read2st64_b64 v[148:151], v2 offset0:10 offset1:11
    ds_read2st64_b64 v[152:155], v2 offset0:12 offset1:13
    ds_read2st64_b64 v[156:159], v2 offset0:14 offset1:15
    ds_read2st64_b64 v[160:163], v2 offset0:16 offset1:17
    ds_read2st64_b64 v[164:167], v2 offset0:18 offset1:19
    ds_read2st64_b64 v[168:171], v2 offset0:20 offset1:21
    ds_read2st64_b64 v[172:175], v2 offset0:22 offset1:23
    ds_read2st64_b64 v[176:179], v2 offset0:24 offset1:25
    ds_read2st64_b64 v[180:183], v2 offset0:26 offset1:27
    ds_read2st64_b64 v[184:187], v2 offset0:28 offset1:29
    ds_read2st64_b64 v[188:191], v2 offset0:30 offset1:31
    s_waitcnt lgkmcnt(0)
    s_nop 0
    v_pk_add_f32 v[128:129], v[128:129], v[160:161]
    v_pk_add_f32 v[130:131], v[130:131], v[162:163]
    v_pk_add_f32 v[132:133], v[132:133], v[164:165]
    v_pk_add_f32 v[134:135], v[134:135], v[166:167]
    v_pk_add_f32 v[136:137], v[136:137], v[168:169]
    v_pk_add_f32 v[138:139], v[138:139], v[170:171]
    v_pk_add_f32 v[140:141], v[140:141], v[172:173]
    v_pk_add_f32 v[142:143], v[142:143], v[174:175]
    v_pk_add_f32 v[144:145], v[144:145], v[176:177]
    v_pk_add_f32 v[146:147], v[146:147], v[178:179]
    v_pk_add_f32 v[148:149], v[148:149], v[180:181]
    v_pk_add_f32 v[150:151], v[150:151], v[182:183]
    v_pk_add_f32 v[152:153], v[152:153], v[184:185]
    v_pk_add_f32 v[154:155], v[154:155], v[186:187]
    v_pk_add_f32 v[156:157], v[156:157], v[188:189]
    v_pk_add_f32 v[158:159], v[158:159], v[190:191]
    v_pk_add_f32 v[128:129], v[128:129], v[144:145]
    v_pk_add_f32 v[130:131], v[130:131], v[146:147]
    v_pk_add_f32 v[132:133], v[132:133], v[148:149]
    v_pk_add_f32 v[134:135], v[134:135], v[150:151]
    v_pk_add_f32 v[136:137], v[136:137], v[152:153]
    v_pk_add_f32 v[138:139], v[138:139], v[154:155]
    v_pk_add_f32 v[140:141], v[140:141], v[156:157]
    v_pk_add_f32 v[142:143], v[142:143], v[158:159]
    v_pk_add_f32 v[128:129], v[128:129], v[136:137]
    v_pk_add_f32 v[130:131], v[130:131], v[138:139]
    v_pk_add_f32 v[132:133], v[132:133], v[140:141]
    v_pk_add_f32 v[134:135], v[134:135], v[142:143]
    v_pk_add_f32 v[128:129], v[128:129], v[132:133]
    v_pk_add_f32 v[130:131], v[130:131], v[134:135]
    v_pk_add_f32 v[128:129], v[128:129], v[130:131]
    v_cvt_pk_bf16_f32 v8, v128, v128
    v_and_b32 v8, s6, v8
    v_sub_f32 v9, v128, v8
    v_cvt_pk_bf16_f32 v4, v128, v9
    v_and_b32 v8, s6, v4
    v_sub_f32 v9, v9, v8
    v_cvt_pk_bf16_f32 v5, v9, v255
    v_cvt_pk_bf16_f32 v8, v129, v129
    v_and_b32 v8, s6, v8
    v_sub_f32 v9, v129, v8
    v_cvt_pk_bf16_f32 v6, v129, v9
    v_and_b32 v8, s6, v6
    v_sub_f32 v9, v9, v8
    v_cvt_pk_bf16_f32 v7, v9, v255
    buffer_store_dwordx4 v[4:7], v1, s[52:55], s65 offen sc1
    s_waitcnt vmcnt(0)
    buffer_store_dword v254, v252, s[52:55], s68 offen sc1
    s_branch L_h_end
L_h_nosum:
    s_cmp_lg_u32 s2, 31
    s_cbranch_scc1 L_h_end
    v_lshlrev_b32_e64 v8, 7, v0
    s_mov_b32 s4, 98304
    s_mov_b32 s85, 0
L_poll_12:
    buffer_load_dword v4, v8, s[52:55], s4 offen offset:0 sc1
    s_waitcnt vmcnt(0)
    v_cmp_ne_u32 vcc, s80, v4
    s_cmp_eq_u64 vcc, 0
    s_cbranch_scc1 L_pdone_13
    s_mov_b64 exec, vcc
    s_sleep 2
    s_add_u32 s85, s85, 1
    s_cmp_lt_u32 s85, 0x8000
    s_cbranch_scc1 L_poll_12
L_pdone_13:
    s_mov_b64 exec, -1
    s_add_u32 s4, s4, 8192
    s_mov_b32 s85, 0
L_poll_14:
    buffer_load_dword v4, v8, s[52:55], s4 offen offset:0 sc1
    s_waitcnt vmcnt(0)
    v_cmp_ne_u32 vcc, s80, v4
    s_cmp_eq_u64 vcc, 0
    s_cbranch_scc1 L_pdone_15
    s_mov_b64 exec, vcc
    s_sleep 2
    s_add_u32 s85, s85, 1
    s_cmp_lt_u32 s85, 0x8000
    s_cbranch_scc1 L_poll_14
L_pdone_15:
    s_mov_b64 exec, -1
    s_add_u32 s4, s4, 8192
    s_mov_b32 s85, 0
L_poll_16:
    buffer_load_dword v4, v8, s[52:55], s4 offen offset:0 sc1
    s_waitcnt vmcnt(0)
    v_cmp_ne_u32 vcc, s80, v4
    s_cmp_eq_u64 vcc, 0
    s_cbranch_scc1 L_pdone_17
    s_mov_b64 exec, vcc
    s_sleep 2
    s_add_u32 s85, s85, 1
    s_cmp_lt_u32 s85, 0x8000
    s_cbranch_scc1 L_poll_16
L_pdone_17:
    s_mov_b64 exec, -1
    s_add_u32 s4, s4, 8192
    s_mov_b32 s85, 0
L_poll_18:
    buffer_load_dword v4, v8, s[52:55], s4 offen offset:0 sc1
    s_waitcnt vmcnt(0)
    v_cmp_ne_u32 vcc, s80, v4
    s_cmp_eq_u64 vcc, 0
    s_cbranch_scc1 L_pdone_19
    s_mov_b64 exec, vcc
    s_sleep 2
    s_add_u32 s85, s85, 1
    s_cmp_lt_u32 s85, 0x8000
    s_cbranch_scc1 L_poll_18
L_pdone_19:
    s_mov_b64 exec, -1
    v_mov_b32 v4, s80
    v_mov_b32 v5, s80
    v_mov_b32 v6, s80
    v_mov_b32 v7, s80
    s_mov_b32 s4, 4096
    buffer_store_dwordx4 v[4:7], v1, s[52:55], s4 offen sc1
    buffer_store_dword v254, v252, s[52:55], 0 offen sc1
L_h_end:
    s_endpgm
.p2align 8
.type L_wgtab,@object
L_wgtab:
.long 131072,0,98304,4096,0,65536,0,0,8192,0,0,0,0,0,0,0
.long 133120,0,98432,4224,0,72704,0,0,9984,0,0,0,1792,0,0,0
.long 135168,0,98560,4352,0,67584,0,0,8704,0,0,0,512,0,0,4
.long 137216,0,98688,4480,0,74752,0,0,10496,0,0,0,2304,0,0,4
.long 139264,0,98816,4608,0,69632,0,0,9216,0,0,0,1024,0,0,8
.long 141312,0,98944,4736,0,76800,0,0,11008,0,0,0,2816,0,0,8
.long 143360,0,99072,4864,0,71680,0,0,9728,0,0,0,1536,0,0,12
.long 145408,0,99200,4992,0,78848,0,0,11520,0,0,0,3328,0,0,12
.long 131136,0,99328,4096,0,79872,0,0,8320,32768,0,0,0,0,0,1
.long 133184,0,99456,4224,0,87040,0,0,10112,32768,0,0,1792,0,0,1
.long 135232,0,99584,4352,0,81920,0,0,8832,32768,0,0,512,0,0,5
.long 137280,0,99712,4480,0,89088,0,0,10624,32768,0,0,2304,0,0,5
.long 139328,0,99840,4608,0,83968,0,0,9344,32768,0,0,1024,0,0,9
.long 141376,0,99968,4736,0,91136,0,0,11136,32768,0,0,2816,0,0,9
.long 143424,0,100096,4864,0,86016,0,0,9856,32768,0,0,1536,0,0,13
.long 145472,0,100224,4992,0,93184,0,0,11648,32768,0,0,3328,0,0,13
.long 131200,0,100352,4096,0,66560,0,0,8448,65536,0,0,256,0,0,2
.long 133248,0,100480,4224,0,73728,0,0,10240,65536,0,0,2048,0,0,2
.long 135296,0,100608,4352,0,68608,0,0,8960,65536,0,0,768,0,0,6
.long 137344,0,100736,4480,0,75776,0,0,10752,65536,0,0,2560,0,0,6
.long 139392,0,100864,4608,0,70656,0,0,9472,65536,0,0,1280,0,0,10
.long 141440,0,100992,4736,0,77824,0,0,11264,65536,0,0,3072,0,0,10
.long 143488,0,101120,4864,0,72704,0,0,9984,65536,0,0,1792,0,0,14
.long 145536,0,101248,4992,0,79872,0,0,11776,65536,0,0,3584,0,0,14
.long 131264,0,101376,4096,0,80896,0,0,8576,98304,0,0,256,0,0,3
.long 133312,0,101504,4224,0,88064,0,0,10368,98304,0,0,2048,0,0,3
.long 135360,0,101632,4352,0,82944,0,0,9088,98304,0,0,768,0,0,7
.long 137408,0,101760,4480,0,90112,0,0,10880,98304,0,0,2560,0,0,7
.long 139456,0,101888,4608,0,84992,0,0,9600,98304,0,0,1280,0,0,11
.long 141504,0,102016,4736,0,92160,0,0,11392,98304,0,0,3072,0,0,11
.long 143552,0,102144,4864,0,87040,0,0,10112,98304,0,0,1792,0,0,15
.long 145600,0,102272,4992,0,94208,0,0,11904,98304,0,0,3584,0,0,15
.long 131328,2097152,102400,4096,1966080,51200,131072,6291456,13631488,0,6291456,13631488,0,2097152,28672,8064
.long 133376,2326528,102528,4224,1966080,58368,360448,6520832,13635072,0,7208960,13664256,229376,2098176,258048,9856
.long 135424,2555904,102656,4352,1970176,51200,589824,8126464,13697024,0,8126464,13697024,458752,2099200,487424,8064
.long 137472,2785280,102784,4480,1970176,58368,819200,8355840,13700608,0,9043968,13729792,688128,2100224,716800,9856
.long 139520,3014656,102912,4608,1974272,51200,1048576,9961472,13762560,0,9961472,13762560,917504,2101248,946176,8064
.long 141568,3244032,103040,4736,1974272,58368,1277952,10190848,13766144,0,10878976,13795328,1146880,2102272,1175552,9856
.long 143616,3473408,103168,4864,1978368,51200,1507328,11796480,13828096,0,11796480,13828096,1376256,2103296,1404928,8064
.long 145664,3702784,103296,4992,1978368,58368,1736704,12025856,13831680,0,12713984,13860864,1605632,2104320,1634304,9856
.long 131392,2105344,103424,4096,1967104,51200,131104,6750208,13647872,0,6307840,13639680,57344,2097408,86016,8064
.long 133440,2334720,103552,4224,1967104,58368,360480,6979584,13651456,0,7225344,13672448,286720,2098432,315392,9856
.long 135488,2564096,103680,4352,1971200,51200,589856,8585216,13713408,0,8142848,13705216,516096,2099456,544768,8064
.long 137536,2793472,103808,4480,1971200,58368,819232,8814592,13716992,0,9060352,13737984,745472,2100480,774144,9856
.long 139584,3022848,103936,4608,1975296,51200,1048608,10420224,13778944,0,9977856,13770752,974848,2101504,1003520,8064
.long 141632,3252224,104064,4736,1975296,58368,1277984,10649600,13782528,0,10895360,13803520,1204224,2102528,1232896,9856
.long 143680,3481600,104192,4864,1979392,51200,1507360,12255232,13844480,0,11812864,13836288,1433600,2103552,1462272,8064
.long 145728,3710976,104320,4992,1979392,58368,1736736,12484608,13848064,0,12730368,13869056,1662976,2104576,1691648,9856
.long 131456,2113536,104448,4096,1968128,51200,147456,7208960,13664256,0,6750208,13647872,114688,2097664,143360,8064
.long 133504,2342912,104576,4224,1968128,58368,376832,7438336,13667840,0,7667712,13680640,344064,2098688,372736,9856
.long 135552,2572288,104704,4352,1972224,51200,606208,9043968,13729792,0,8585216,13713408,573440,2099712,602112,8064
.long 137600,2801664,104832,4480,1972224,58368,835584,9273344,13733376,0,9502720,13746176,802816,2100736,831488,9856
.long 139648,3031040,104960,4608,1976320,51200,1064960,10878976,13795328,0,10420224,13778944,1032192,2101760,1060864,8064
.long 141696,3260416,105088,4736,1976320,58368,1294336,11108352,13798912,0,11337728,13811712,1261568,2102784,1290240,9856
.long 143744,3489792,105216,4864,1980416,51200,1523712,12713984,13860864,0,12255232,13844480,1490944,2103808,1519616,8064
.long 145792,3719168,105344,4992,1980416,58368,1753088,12943360,13864448,0,13172736,13877248,1720320,2104832,1748992,9856
.long 131520,2121728,105472,4096,1969152,51200,147488,7667712,13680640,0,6766592,13656064,172032,2097920,200704,8064
.long 133568,2351104,105600,4224,1969152,58368,376864,7897088,13684224,0,7684096,13688832,401408,2098944,430080,9856
.long 135616,2580480,105728,4352,1973248,51200,606240,9502720,13746176,0,8601600,13721600,630784,2099968,659456,8064
.long 137664,2809856,105856,4480,1973248,58368,835616,9732096,13749760,0,9519104,13754368,860160,2100992,888832,9856
.long 139712,3039232,105984,4608,1977344,51200,1064992,11337728,13811712,0,10436608,13787136,1089536,2102016,1118208,8064
.long 141760,3268608,106112,4736,1977344,58368,1294368,11567104,13815296,0,11354112,13819904,1318912,2103040,1347584,9856
.long 143808,3497984,106240,4864,1981440,51200,1523744,13172736,13877248,0,12271616,13852672,1548288,2104064,1576960,8064
.long 145856,3727360,106368,4992,1981440,58368,1753120,13402112,13880832,0,13189120,13885440,1777664,2105088,1806336,9856
.long 131584,2129920,106496,4096,1966080,52224,163840,6324224,13632000,128,6291456,13631488,128,2359296,28800,8320
.long 133632,2359296,106624,4224,1966080,59392,393216,6553600,13635584,128,7208960,13664256,229504,2360320,258176,10112
.long 135680,2588672,106752,4352,1970176,52224,622592,8159232,13697536,128,8126464,13697024,458880,2361344,487552,8320
.long 137728,2818048,106880,4480,1970176,59392,851968,8388608,13701120,128,9043968,13729792,688256,2362368,716928,10112
.long 139776,3047424,107008,4608,1974272,52224,1081344,9994240,13763072,128,9961472,13762560,917632,2363392,946304,8320
.long 141824,3276800,107136,4736,1974272,59392,1310720,10223616,13766656,128,10878976,13795328,1147008,2364416,1175680,10112
.long 143872,3506176,107264,4864,1978368,52224,1540096,11829248,13828608,128,11796480,13828096,1376384,2365440,1405056,8320
.long 145920,3735552,107392,4992,1978368,59392,1769472,12058624,13832192,128,12713984,13860864,1605760,2366464,1634432,10112
.long 131648,2138112,107520,4096,1967104,52224,163872,6782976,13648384,128,6307840,13639680,57472,2359552,86144,8320
.long 133696,2367488,107648,4224,1967104,59392,393248,7012352,13651968,128,7225344,13672448,286848,2360576,315520,10112
.long 135744,2596864,107776,4352,1971200,52224,622624,8617984,13713920,128,8142848,13705216,516224,2361600,544896,8320
.long 137792,2826240,107904,4480,1971200,59392,852000,8847360,13717504,128,9060352,13737984,745600,2362624,774272,10112
.long 139840,3055616,108032,4608,1975296,52224,1081376,10452992,13779456,128,9977856,13770752,974976,2363648,1003648,8320
.long 141888,3284992,108160,4736,1975296,59392,1310752,10682368,13783040,128,10895360,13803520,1204352,2364672,1233024,10112
.long 143936,3514368,108288,4864,1979392,52224,1540128,12288000,13844992,128,11812864,13836288,1433728,2365696,1462400,8320
.long 145984,3743744,108416,4992,1979392,59392,1769504,12517376,13848576,128,12730368,13869056,1663104,2366720,1691776,10112
.long 131712,2146304,108544,4096,1968128,52224,180224,7241728,13664768,128,6750208,13647872,114816,2359808,143488,8320
.long 133760,2375680,108672,4224,1968128,59392,409600,7471104,13668352,128,7667712,13680640,344192,2360832,372864,10112
.long 135808,2605056,108800,4352,1972224,52224,638976,9076736,13730304,128,8585216,13713408,573568,2361856,602240,8320
.long 137856,2834432,108928,4480,1972224,59392,868352,9306112,13733888,128,9502720,13746176,802944,2362880,831616,10112
.long 139904,3063808,109056,4608,1976320,52224,1097728,10911744,13795840,128,10420224,13778944,1032320,2363904,1060992,8320
.long 141952,3293184,109184,4736,1976320,59392,1327104,11141120,13799424,128,11337728,13811712,1261696,2364928,1290368,10112
.long 144000,3522560,109312,4864,1980416,52224,1556480,12746752,13861376,128,12255232,13844480,1491072,2365952,1519744,8320
.long 146048,3751936,109440,4992,1980416,59392,1785856,12976128,13864960,128,13172736,13877248,1720448,2366976,1749120,10112
.long 131776,2154496,109568,4096,1969152,52224,180256,7700480,13681152,128,6766592,13656064,172160,2360064,200832,8320
.long 133824,2383872,109696,4224,1969152,59392,409632,7929856,13684736,128,7684096,13688832,401536,2361088,430208,10112
.long 135872,2613248,109824,4352,1973248,52224,639008,9535488,13746688,128,8601600,13721600,630912,2362112,659584,8320
.long 137920,2842624,109952,4480,1973248,59392,868384,9764864,13750272,128,9519104,13754368,860288,2363136,888960,10112
.long 139968,3072000,110080,4608,1977344,52224,1097760,11370496,13812224,128,10436608,13787136,1089664,2364160,1118336,8320
.long 142016,3301376,110208,4736,1977344,59392,1327136,11599872,13815808,128,11354112,13819904,1319040,2365184,1347712,10112
.long 144064,3530752,110336,4864,1981440,52224,1556512,13205504,13877760,128,12271616,13852672,1548416,2366208,1577088,8320
.long 146112,3760128,110464,4992,1981440,59392,1785888,13434880,13881344,128,13189120,13885440,1777792,2367232,1806464,10112
.long 131840,2162688,110592,4096,1966080,53248,196608,6356992,13632512,256,6291456,13631488,256,2621440,28928,8576
.long 133888,2392064,110720,4224,1966080,60416,425984,6586368,13636096,256,7208960,13664256,229632,2622464,258304,10368
.long 135936,2621440,110848,4352,1970176,53248,655360,8192000,13698048,256,8126464,13697024,459008,2623488,487680,8576
.long 137984,2850816,110976,4480,1970176,60416,884736,8421376,13701632,256,9043968,13729792,688384,2624512,717056,10368
.long 140032,3080192,111104,4608,1974272,53248,1114112,10027008,13763584,256,9961472,13762560,917760,2625536,946432,8576
.long 142080,3309568,111232,4736,1974272,60416,1343488,10256384,13767168,256,10878976,13795328,1147136,2626560,1175808,10368
.long 144128,3538944,111360,4864,1978368,53248,1572864,11862016,13829120,256,11796480,13828096,1376512,2627584,1405184,8576
.long 146176,3768320,111488,4992,1978368,60416,1802240,12091392,13832704,256,12713984,13860864,1605888,2628608,1634560,10368
.long 131904,2170880,111616,4096,1967104,53248,196640,6815744,13648896,256,6307840,13639680,57600,2621696,86272,8576
.long 133952,2400256,111744,4224,1967104,60416,426016,7045120,13652480,256,7225344,13672448,286976,2622720,315648,10368
.long 136000,2629632,111872,4352,1971200,53248,655392,8650752,13714432,256,8142848,13705216,516352,2623744,545024,8576
.long 138048,2859008,112000,4480,1971200,60416,884768,8880128,13718016,256,9060352,13737984,745728,2624768,774400,10368
.long 140096,3088384,112128,4608,1975296,53248,1114144,10485760,13779968,256,9977856,13770752,975104,2625792,1003776,8576
.long 142144,3317760,112256,4736,1975296,60416,1343520,10715136,13783552,256,10895360,13803520,1204480,2626816,1233152,10368
.long 144192,3547136,112384,4864,1979392,53248,1572896,12320768,13845504,256,11812864,13836288,1433856,2627840,1462528,8576
.long 146240,3776512,112512,4992,1979392,60416,1802272,12550144,13849088,256,12730368,13869056,1663232,2628864,1691904,10368
.long 131968,2179072,112640,4096,1968128,53248,212992,7274496,13665280,256,6750208,13647872,114944,2621952,143616,8576
.long 134016,2408448,112768,4224,1968128,60416,442368,7503872,13668864,256,7667712,13680640,344320,2622976,372992,10368
.long 136064,2637824,112896,4352,1972224,53248,671744,9109504,13730816,256,8585216,13713408,573696,2624000,602368,8576
.long 138112,2867200,113024,4480,1972224,60416,901120,9338880,13734400,256,9502720,13746176,803072,2625024,831744,10368
.long 140160,3096576,113152,4608,1976320,53248,1130496,10944512,13796352,256,10420224,13778944,1032448,2626048,1061120,8576
.long 142208,3325952,113280,4736,1976320,60416,1359872,11173888,13799936,256,11337728,13811712,1261824,2627072,1290496,10368
.long 144256,3555328,113408,4864,1980416,53248,1589248,12779520,13861888,256,12255232,13844480,1491200,2628096,1519872,8576
.long 146304,3784704,113536,4992,1980416,60416,1818624,13008896,13865472,256,13172736,13877248,1720576,2629120,1749248,10368
.long 132032,2187264,113664,4096,1969152,53248,213024,7733248,13681664,256,6766592,13656064,172288,2622208,200960,8576
.long 134080,2416640,113792,4224,1969152,60416,442400,7962624,13685248,256,7684096,13688832,401664,2623232,430336,10368
.long 136128,2646016,113920,4352,1973248,53248,671776,9568256,13747200,256,8601600,13721600,631040,2624256,659712,8576
.long 138176,2875392,114048,4480,1973248,60416,901152,9797632,13750784,256,9519104,13754368,860416,2625280,889088,10368
.long 140224,3104768,114176,4608,1977344,53248,1130528,11403264,13812736,256,10436608,13787136,1089792,2626304,1118464,8576
.long 142272,3334144,114304,4736,1977344,60416,1359904,11632640,13816320,256,11354112,13819904,1319168,2627328,1347840,10368
.long 144320,3563520,114432,4864,1981440,53248,1589280,13238272,13878272,256,12271616,13852672,1548544,2628352,1577216,8576
.long 146368,3792896,114560,4992,1981440,60416,1818656,13467648,13881856,256,13189120,13885440,1777920,2629376,1806592,10368
.long 132096,2195456,114688,4096,1966080,54272,229376,6389760,13633024,384,6291456,13631488,384,2883584,29056,8832
.long 134144,2424832,114816,4224,1966080,61440,458752,6619136,13636608,384,7208960,13664256,229760,2884608,258432,10624
.long 136192,2654208,114944,4352,1970176,54272,688128,8224768,13698560,384,8126464,13697024,459136,2885632,487808,8832
.long 138240,2883584,115072,4480,1970176,61440,917504,8454144,13702144,384,9043968,13729792,688512,2886656,717184,10624
.long 140288,3112960,115200,4608,1974272,54272,1146880,10059776,13764096,384,9961472,13762560,917888,2887680,946560,8832
.long 142336,3342336,115328,4736,1974272,61440,1376256,10289152,13767680,384,10878976,13795328,1147264,2888704,1175936,10624
.long 144384,3571712,115456,4864,1978368,54272,1605632,11894784,13829632,384,11796480,13828096,1376640,2889728,1405312,8832
.long 146432,3801088,115584,4992,1978368,61440,1835008,12124160,13833216,384,12713984,13860864,1606016,2890752,1634688,10624
.long 132160,2203648,115712,4096,1967104,54272,229408,6848512,13649408,384,6307840,13639680,57728,2883840,86400,8832
.long 134208,2433024,115840,4224,1967104,61440,458784,7077888,13652992,384,7225344,13672448,287104,2884864,315776,10624
.long 136256,2662400,115968,4352,1971200,54272,688160,8683520,13714944,384,8142848,13705216,516480,2885888,545152,8832
.long 138304,2891776,116096,4480,1971200,61440,917536,8912896,13718528,384,9060352,13737984,745856,2886912,774528,10624
.long 140352,3121152,116224,4608,1975296,54272,1146912,10518528,13780480,384,9977856,13770752,975232,2887936,1003904,8832
.long 142400,3350528,116352,4736,1975296,61440,1376288,10747904,13784064,384,10895360,13803520,1204608,2888960,1233280,10624
.long 144448,3579904,116480,4864,1979392,54272,1605664,12353536,13846016,384,11812864,13836288,1433984,2889984,1462656,8832
.long 146496,3809280,116608,4992,1979392,61440,1835040,12582912,13849600,384,12730368,13869056,1663360,2891008,1692032,10624
.long 132224,2211840,116736,4096,1968128,54272,245760,7307264,13665792,384,6750208,13647872,115072,2884096,143744,8832
.long 134272,2441216,116864,4224,1968128,61440,475136,7536640,13669376,384,7667712,13680640,344448,2885120,373120,10624
.long 136320,2670592,116992,4352,1972224,54272,704512,9142272,13731328,384,8585216,13713408,573824,2886144,602496,8832
.long 138368,2899968,117120,4480,1972224,61440,933888,9371648,13734912,384,9502720,13746176,803200,2887168,831872,10624
.long 140416,3129344,117248,4608,1976320,54272,1163264,10977280,13796864,384,10420224,13778944,1032576,2888192,1061248,8832
.long 142464,3358720,117376,4736,1976320,61440,1392640,11206656,13800448,384,11337728,13811712,1261952,2889216,1290624,10624
.long 144512,3588096,117504,4864,1980416,54272,1622016,12812288,13862400,384,12255232,13844480,1491328,2890240,1520000,8832
.long 146560,3817472,117632,4992,1980416,61440,1851392,13041664,13865984,384,13172736,13877248,1720704,2891264,1749376,10624
.long 132288,2220032,117760,4096,1969152,54272,245792,7766016,13682176,384,6766592,13656064,172416,2884352,201088,8832
.long 134336,2449408,117888,4224,1969152,61440,475168,7995392,13685760,384,7684096,13688832,401792,2885376,430464,10624
.long 136384,2678784,118016,4352,1973248,54272,704544,9601024,13747712,384,8601600,13721600,631168,2886400,659840,8832
.long 138432,2908160,118144,4480,1973248,61440,933920,9830400,13751296,384,9519104,13754368,860544,2887424,889216,10624
.long 140480,3137536,118272,4608,1977344,54272,1163296,11436032,13813248,384,10436608,13787136,1089920,2888448,1118592,8832
.long 142528,3366912,118400,4736,1977344,61440,1392672,11665408,13816832,384,11354112,13819904,1319296,2889472,1347968,10624
.long 144576,3596288,118528,4864,1981440,54272,1622048,13271040,13878784,384,12271616,13852672,1548672,2890496,1577344,8832
.long 146624,3825664,118656,4992,1981440,61440,1851424,13500416,13882368,384,13189120,13885440,1778048,2891520,1806720,10624
.long 132352,2228224,118784,4096,1966080,55296,262144,6422528,13633536,512,6291456,13631488,512,3145728,29184,9088
.long 134400,2457600,118912,4224,1966080,62464,491520,6651904,13637120,512,7208960,13664256,229888,3146752,258560,10880
.long 136448,2686976,119040,4352,1970176,55296,720896,8257536,13699072,512,8126464,13697024,459264,3147776,487936,9088
.long 138496,2916352,119168,4480,1970176,62464,950272,8486912,13702656,512,9043968,13729792,688640,3148800,717312,10880
.long 140544,3145728,119296,4608,1974272,55296,1179648,10092544,13764608,512,9961472,13762560,918016,3149824,946688,9088
.long 142592,3375104,119424,4736,1974272,62464,1409024,10321920,13768192,512,10878976,13795328,1147392,3150848,1176064,10880
.long 144640,3604480,119552,4864,1978368,55296,1638400,11927552,13830144,512,11796480,13828096,1376768,3151872,1405440,9088
.long 146688,3833856,119680,4992,1978368,62464,1867776,12156928,13833728,512,12713984,13860864,1606144,3152896,1634816,10880
.long 132416,2236416,119808,4096,1967104,55296,262176,6881280,13649920,512,6307840,13639680,57856,3145984,86528,9088
.long 134464,2465792,119936,4224,1967104,62464,491552,7110656,13653504,512,7225344,13672448,287232,3147008,315904,10880
.long 136512,2695168,120064,4352,1971200,55296,720928,8716288,13715456,512,8142848,13705216,516608,3148032,545280,9088
.long 138560,2924544,120192,4480,1971200,62464,950304,8945664,13719040,512,9060352,13737984,745984,3149056,774656,10880
.long 140608,3153920,120320,4608,1975296,55296,1179680,10551296,13780992,512,9977856,13770752,975360,3150080,1004032,9088
.long 142656,3383296,120448,4736,1975296,62464,1409056,10780672,13784576,512,10895360,13803520,1204736,3151104,1233408,10880
.long 144704,3612672,120576,4864,1979392,55296,1638432,12386304,13846528,512,11812864,13836288,1434112,3152128,1462784,9088
.long 146752,3842048,120704,4992,1979392,62464,1867808,12615680,13850112,512,12730368,13869056,1663488,3153152,1692160,10880
.long 132480,2244608,120832,4096,1968128,55296,278528,7340032,13666304,512,6750208,13647872,115200,3146240,143872,9088
.long 134528,2473984,120960,4224,1968128,62464,507904,7569408,13669888,512,7667712,13680640,344576,3147264,373248,10880
.long 136576,2703360,121088,4352,1972224,55296,737280,9175040,13731840,512,8585216,13713408,573952,3148288,602624,9088
.long 138624,2932736,121216,4480,1972224,62464,966656,9404416,13735424,512,9502720,13746176,803328,3149312,832000,10880
.long 140672,3162112,121344,4608,1976320,55296,1196032,11010048,13797376,512,10420224,13778944,1032704,3150336,1061376,9088
.long 142720,3391488,121472,4736,1976320,62464,1425408,11239424,13800960,512,11337728,13811712,1262080,3151360,1290752,10880
.long 144768,3620864,121600,4864,1980416,55296,1654784,12845056,13862912,512,12255232,13844480,1491456,3152384,1520128,9088
.long 146816,3850240,121728,4992,1980416,62464,1884160,13074432,13866496,512,13172736,13877248,1720832,3153408,1749504,10880
.long 132544,2252800,121856,4096,1969152,55296,278560,7798784,13682688,512,6766592,13656064,172544,3146496,201216,9088
.long 134592,2482176,121984,4224,1969152,62464,507936,8028160,13686272,512,7684096,13688832,401920,3147520,430592,10880
.long 136640,2711552,122112,4352,1973248,55296,737312,9633792,13748224,512,8601600,13721600,631296,3148544,659968,9088
.long 138688,2940928,122240,4480,1973248,62464,966688,9863168,13751808,512,9519104,13754368,860672,3149568,889344,10880
.long 140736,3170304,122368,4608,1977344,55296,1196064,11468800,13813760,512,10436608,13787136,1090048,3150592,1118720,9088
.long 142784,3399680,122496,4736,1977344,62464,1425440,11698176,13817344,512,11354112,13819904,1319424,3151616,1348096,10880
.long 144832,3629056,122624,4864,1981440,55296,1654816,13303808,13879296,512,12271616,13852672,1548800,3152640,1577472,9088
.long 146880,3858432,122752,4992,1981440,62464,1884192,13533184,13882880,512,13189120,13885440,1778176,3153664,1806848,10880
.long 132608,2260992,122880,4096,1966080,56320,294912,6455296,13634048,640,6291456,13631488,640,3407872,29312,9344
.long 134656,2490368,123008,4224,1966080,63488,524288,6684672,13637632,640,7208960,13664256,230016,3408896,258688,11136
.long 136704,2719744,123136,4352,1970176,56320,753664,8290304,13699584,640,8126464,13697024,459392,3409920,488064,9344
.long 138752,2949120,123264,4480,1970176,63488,983040,8519680,13703168,640,9043968,13729792,688768,3410944,717440,11136
.long 140800,3178496,123392,4608,1974272,56320,1212416,10125312,13765120,640,9961472,13762560,918144,3411968,946816,9344
.long 142848,3407872,123520,4736,1974272,63488,1441792,10354688,13768704,640,10878976,13795328,1147520,3412992,1176192,11136
.long 144896,3637248,123648,4864,1978368,56320,1671168,11960320,13830656,640,11796480,13828096,1376896,3414016,1405568,9344
.long 146944,3866624,123776,4992,1978368,63488,1900544,12189696,13834240,640,12713984,13860864,1606272,3415040,1634944,11136
.long 132672,2269184,123904,4096,1967104,56320,294944,6914048,13650432,640,6307840,13639680,57984,3408128,86656,9344
.long 134720,2498560,124032,4224,1967104,63488,524320,7143424,13654016,640,7225344,13672448,287360,3409152,316032,11136
.long 136768,2727936,124160,4352,1971200,56320,753696,8749056,13715968,640,8142848,13705216,516736,3410176,545408,9344
.long 138816,2957312,124288,4480,1971200,63488,983072,8978432,13719552,640,9060352,13737984,746112,3411200,774784,11136
.long 140864,3186688,124416,4608,1975296,56320,1212448,10584064,13781504,640,9977856,13770752,975488,3412224,1004160,9344
.long 142912,3416064,124544,4736,1975296,63488,1441824,10813440,13785088,640,10895360,13803520,1204864,3413248,1233536,11136
.long 144960,3645440,124672,4864,1979392,56320,1671200,12419072,13847040,640,11812864,13836288,1434240,3414272,1462912,9344
.long 147008,3874816,124800,4992,1979392,63488,1900576,12648448,13850624,640,12730368,13869056,1663616,3415296,1692288,11136
.long 132736,2277376,124928,4096,1968128,56320,311296,7372800,13666816,640,6750208,13647872,115328,3408384,144000,9344
.long 134784,2506752,125056,4224,1968128,63488,540672,7602176,13670400,640,7667712,13680640,344704,3409408,373376,11136
.long 136832,2736128,125184,4352,1972224,56320,770048,9207808,13732352,640,8585216,13713408,574080,3410432,602752,9344
.long 138880,2965504,125312,4480,1972224,63488,999424,9437184,13735936,640,9502720,13746176,803456,3411456,832128,11136
.long 140928,3194880,125440,4608,1976320,56320,1228800,11042816,13797888,640,10420224,13778944,1032832,3412480,1061504,9344
.long 142976,3424256,125568,4736,1976320,63488,1458176,11272192,13801472,640,11337728,13811712,1262208,3413504,1290880,11136
.long 145024,3653632,125696,4864,1980416,56320,1687552,12877824,13863424,640,12255232,13844480,1491584,3414528,1520256,9344
.long 147072,3883008,125824,4992,1980416,63488,1916928,13107200,13867008,640,13172736,13877248,1720960,3415552,1749632,11136
.long 132800,2285568,125952,4096,1969152,56320,311328,7831552,13683200,640,6766592,13656064,172672,3408640,201344,9344
.long 134848,2514944,126080,4224,1969152,63488,540704,8060928,13686784,640,7684096,13688832,402048,3409664,430720,11136
.long 136896,2744320,126208,4352,1973248,56320,770080,9666560,13748736,640,8601600,13721600,631424,3410688,660096,9344
.long 138944,2973696,126336,4480,1973248,63488,999456,9895936,13752320,640,9519104,13754368,860800,3411712,889472,11136
.long 140992,3203072,126464,4608,1977344,56320,1228832,11501568,13814272,640,10436608,13787136,1090176,3412736,1118848,9344
.long 143040,3432448,126592,4736,1977344,63488,1458208,11730944,13817856,640,11354112,13819904,1319552,3413760,1348224,11136
.long 145088,3661824,126720,4864,1981440,56320,1687584,13336576,13879808,640,12271616,13852672,1548928,3414784,1577600,9344
.long 147136,3891200,126848,4992,1981440,63488,1916960,13565952,13883392,640,13189120,13885440,1778304,3415808,1806976,11136
.long 132864,2293760,126976,4096,1966080,57344,327680,6488064,13634560,768,6291456,13631488,768,3670016,29440,9600
.long 134912,2523136,127104,4224,1966080,64512,557056,6717440,13638144,768,7208960,13664256,230144,3671040,258816,11392
.long 136960,2752512,127232,4352,1970176,57344,786432,8323072,13700096,768,8126464,13697024,459520,3672064,488192,9600
.long 139008,2981888,127360,4480,1970176,64512,1015808,8552448,13703680,768,9043968,13729792,688896,3673088,717568,11392
.long 141056,3211264,127488,4608,1974272,57344,1245184,10158080,13765632,768,9961472,13762560,918272,3674112,946944,9600
.long 143104,3440640,127616,4736,1974272,64512,1474560,10387456,13769216,768,10878976,13795328,1147648,3675136,1176320,11392
.long 145152,3670016,127744,4864,1978368,57344,1703936,11993088,13831168,768,11796480,13828096,1377024,3676160,1405696,9600
.long 147200,3899392,127872,4992,1978368,64512,1933312,12222464,13834752,768,12713984,13860864,1606400,3677184,1635072,11392
.long 132928,2301952,128000,4096,1967104,57344,327712,6946816,13650944,768,6307840,13639680,58112,3670272,86784,9600
.long 134976,2531328,128128,4224,1967104,64512,557088,7176192,13654528,768,7225344,13672448,287488,3671296,316160,11392
.long 137024,2760704,128256,4352,1971200,57344,786464,8781824,13716480,768,8142848,13705216,516864,3672320,545536,9600
.long 139072,2990080,128384,4480,1971200,64512,1015840,9011200,13720064,768,9060352,13737984,746240,3673344,774912,11392
.long 141120,3219456,128512,4608,1975296,57344,1245216,10616832,13782016,768,9977856,13770752,975616,3674368,1004288,9600
.long 143168,3448832,128640,4736,1975296,64512,1474592,10846208,13785600,768,10895360,13803520,1204992,3675392,1233664,11392
.long 145216,3678208,128768,4864,1979392,57344,1703968,12451840,13847552,768,11812864,13836288,1434368,3676416,1463040,9600
.long 147264,3907584,128896,4992,1979392,64512,1933344,12681216,13851136,768,12730368,13869056,1663744,3677440,1692416,11392
.long 132992,2310144,129024,4096,1968128,57344,344064,7405568,13667328,768,6750208,13647872,115456,3670528,144128,9600
.long 135040,2539520,129152,4224,1968128,64512,573440,7634944,13670912,768,7667712,13680640,344832,3671552,373504,11392
.long 137088,2768896,129280,4352,1972224,57344,802816,9240576,13732864,768,8585216,13713408,574208,3672576,602880,9600
.long 139136,2998272,129408,4480,1972224,64512,1032192,9469952,13736448,768,9502720,13746176,803584,3673600,832256,11392
.long 141184,3227648,129536,4608,1976320,57344,1261568,11075584,13798400,768,10420224,13778944,1032960,3674624,1061632,9600
.long 143232,3457024,129664,4736,1976320,64512,1490944,11304960,13801984,768,11337728,13811712,1262336,3675648,1291008,11392
.long 145280,3686400,129792,4864,1980416,57344,1720320,12910592,13863936,768,12255232,13844480,1491712,3676672,1520384,9600
.long 147328,3915776,129920,4992,1980416,64512,1949696,13139968,13867520,768,13172736,13877248,1721088,3677696,1749760,11392
.long 133056,2318336,130048,4096,1969152,57344,344096,7864320,13683712,768,6766592,13656064,172800,3670784,201472,9600
.long 135104,2547712,130176,4224,1969152,64512,573472,8093696,13687296,768,7684096,13688832,402176,3671808,430848,11392
.long 137152,2777088,130304,4352,1973248,57344,802848,9699328,13749248,768,8601600,13721600,631552,3672832,660224,9600
.long 139200,3006464,130432,4480,1973248,64512,1032224,9928704,13752832,768,9519104,13754368,860928,3673856,889600,11392
.long 141248,3235840,130560,4608,1977344,57344,1261600,11534336,13814784,768,10436608,13787136,1090304,3674880,1118976,9600
.long 143296,3465216,130688,4736,1977344,64512,1490976,11763712,13818368,768,11354112,13819904,1319680,3675904,1348352,11392
.long 145344,3694592,130816,4864,1981440,57344,1720352,13369344,13880320,768,12271616,13852672,1549056,3676928,1577728,9600
.long 147392,3923968,130944,4992,1981440,64512,1949728,13598720,13883904,768,13189120,13885440,1778432,3677952,1807104,11392
.size L_wgtab, 16384
.section .rodata,"a"
.p2align 6
.amdhsa_kernel parallel_sum__ssm_conv_s4__glu_gated_glu__prompt_kernel
  .amdhsa_next_free_vgpr 256
  .amdhsa_next_free_sgpr 102
  .amdhsa_accum_offset 256
  .amdhsa_group_segment_fixed_size 0
  .amdhsa_kernarg_size 128
  .amdhsa_user_sgpr_count 2
  .amdhsa_user_sgpr_kernarg_segment_ptr 1
  .amdhsa_system_sgpr_workgroup_id_x 1
.end_amdhsa_kernel
```
